```python
import torch

def _softmax(x, axis=-1):
    return torch.softmax(x, dim=axis)

def _gelu(x):
    return torch.nn.functional.gelu(x, approximate='tanh')

def _silu(x):
    return torch.nn.functional.silu(x)

def _sigmoid(x):
    return torch.sigmoid(x)

def _layernorm(x, axis=-1, eps=1e-05):
    m = x.mean(dim=axis, keepdim=True)
    v = x.var(dim=axis, keepdim=True, unbiased=False)
    return (x - m) / torch.sqrt(v + eps)

def _scatter_add(tgt, idx, src, axis=0):
    return tgt.clone().index_add_(axis, idx, src)

def _segment_sum(src, seg, n):
    out = torch.zeros((n,) + src.shape[1:], dtype=src.dtype)
    return out.index_add_(0, seg, src)

def _pad(x, pw):
    flat = tuple((v for pair in reversed(pw) for v in pair))
    return torch.nn.functional.pad(x, flat)
kernel_name = 'sequential_preLN__spectral_gfnet__mixer_gmlp__prompt'

def setup_inputs():

    _w = lambda a: (lambda t: t.to(torch.bfloat16) if t.is_floating_point() else t)(torch.as_tensor(a))

    def _A_setup():
        B, S, D = (1, 2048, 512)
        Df = D // 2 + 1
        return {'x': _w((lambda *s: torch.randn(*s, dtype=torch.bfloat16) * 0.05)(B, S, D)), 'w_r': _w((lambda *s: torch.randn(*s, dtype=torch.bfloat16) * 0.4)(S, Df) * 0.02), 'w_i': _w((lambda *s: torch.randn(*s, dtype=torch.bfloat16) * 0.4)(S, Df) * 0.02)}
    _A_in = _A_setup()

    def _B_setup():
        B, S, D, F = (1, 2048, 512, 1376)
        Fh = F // 2
        return {'x': _w((lambda *s: torch.randn(*s, dtype=torch.bfloat16) * 0.05)(B, S, D)), 'w_in': _w((lambda *s: torch.randn(*s, dtype=torch.bfloat16) * 0.4)(D, 2 * Fh)), 'w_sp': _w(0.01 * (lambda *s: torch.randn(*s, dtype=torch.bfloat16) * 0.4)(S, S)), 'b_sp': _w(1.0 + 0.01 * (lambda *s: torch.randn(*s, dtype=torch.bfloat16) * 0.05)(S)), 'w_out': _w((lambda *s: torch.randn(*s, dtype=torch.bfloat16) * 0.05)(Fh, D))}
    _B_in = _B_setup()
    return {'A_x': _A_in['x'], 'A_w_r': _A_in['w_r'], 'A_w_i': _A_in['w_i'], 'B_x': _B_in['x'], 'B_w_in': _B_in['w_in'], 'B_w_sp': _B_in['w_sp'], 'B_b_sp': _B_in['b_sp'], 'B_w_out': _B_in['w_out']}

def reference(A_x, A_w_r, A_w_i, B_x, B_w_in, B_w_sp, B_b_sp, B_w_out):

    def _A_ref(x, w_r, w_i):
        B, S, D = x.shape
        X = (lambda x, axes=(-2, -1): torch.fft.rfft2(x.float(), dim=axes))(x, axes=(-2, -1))
        W = w_r + 1j * w_i
        X = X * W
        y = (lambda x, s, axes=(-2, -1): torch.fft.irfft2(x, s=s, dim=axes).to(torch.bfloat16))(X, (S, D), axes=(-2, -1))
        return y

    def _B_ref(x, w_in, w_sp, b_sp, w_out):
        B, S, D = x.shape
        F = w_in.shape[-1]
        Fh = F // 2
        z = _gelu(torch.einsum('bsd,df->bsf', x, w_in))
        z1 = z[..., :Fh].clone()
        z2 = _layernorm(z[..., Fh:], axis=-1)
        g = torch.einsum('ts,bsf->btf', w_sp, z2) + b_sp[None, :, None]
        return torch.einsum('bsf,fd->bsd', z1 * g, w_out)
    x = A_x
    h = x + _A_ref(_layernorm(x, axis=-1), A_w_r, A_w_i)
    h2 = h + _B_ref(_layernorm(h, axis=-1), B_w_in, B_w_sp, B_b_sp, B_w_out)
    return h2
```

```asm
; @launch grid=(256,1,1) block=(256,1,1) lds=163840
.amdgcn_target "amdgcn-amd-amdhsa--gfx950"
.text
.globl sequential_preLN__spectral_gfnet__mixer_gmlp__prompt_kernel
.p2align 8
.type sequential_preLN__spectral_gfnet__mixer_gmlp__prompt_kernel,@function
sequential_preLN__spectral_gfnet__mixer_gmlp__prompt_kernel:
  s_cmp_ge_u32 s2, 256
  s_cbranch_scc1 k_done
  s_load_dwordx16 s[84:99], s[0:1], 0
  s_load_dwordx2 s[8:9], s[0:1], 80
  s_load_dwordx2 s[48:49], s[0:1], 64
  s_getpc_b64 s[44:45]
k_pc:
  s_lshr_b32 s35, s2, 3
  s_cmp_lt_u32 s35, 5
  s_cselect_b32 exec_lo, 0x11111111, 1
  s_cselect_b32 exec_hi, 0x11111111, 0
  s_cselect_b32 s36, s35, 0
  v_lshlrev_b32 v4, 5, v0
  v_lshl_add_u32 v4, s36, 13, v4
  global_load_dword v255, v4, s[44:45]
  s_mov_b64 exec, -1
  v_lshrrev_b32 v4, 6, v0
  v_and_b32 v1, 63, v0
  v_readfirstlane_b32 s34, v4
  v_lshlrev_b32 v240, 4, v1
  s_lshr_b32 s36, s2, 4
  s_lshl_b32 s36, s36, 6
  s_and_b32 s37, s2, 15
  s_add_u32 s36, s36, s37
  s_lshl_b32 s39, s36, 11
  s_mul_i32 s37, s34, 0x10200
  s_and_b32 s37, s37, 0x10400
  s_add_u32 s39, s39, s37
  s_lshl_b32 m0, s34, 11
  s_add_u32 s41, s39, 31744
  s_mov_b32 s18, 2097152
  s_mov_b32 s19, 0x20000
  s_mov_b32 s10, 268435456
  s_mov_b32 s11, 0x20000
  s_mov_b32 s22, 1052672
  s_mov_b32 s23, 0x20000
  s_mov_b32 s26, 1052672
  s_mov_b32 s27, 0x20000
  s_mov_b32 s46, 1409024
  s_mov_b32 s47, 0x20000
  s_and_b32 s36, s2, 63
  s_and_b32 s37, s2, 64
  s_lshl2_add_u32 s36, s37, s36
  s_and_b32 s37, s2, 128
  s_lshl3_add_u32 s36, s37, s36
  s_mul_i32 s42, s36, 514
  s_lshl_b32 s36, s34, 7
  s_add_u32 s42, s42, s36
  v_and_b32 v2, 15, v0
  v_bfe_u32 v3, v0, 4, 2
  v_lshrrev_b32 v245, 3, v1
  v_and_b32 v5, 4, v245
  v_add_u32 v5, v5, v245
  v_mul_u32_u24 v5, 32896, v5
  v_and_b32 v6, 0x70, v240
  v_add3_u32 v5, v5, v6, 2
  s_lshl2_add_u32 s35, s35, s34
  s_mul_i32 s35, s35, 11008
  s_and_b32 s3, s2, 7
  s_mul_i32 s36, s3, 352
  s_add_u32 s5, s35, s36
  v_lshrrev_b32 v6, 2, v1
  v_mul_u32_u24 v6, 2288, v6
  v_mov_b32 v7, 116
  v_mad_u32_u24 v6, v1, v7, v6
  s_mov_b32 s6, 15040512
  s_waitcnt lgkmcnt(0)
  s_mov_b64 s[16:17], s[84:85]
  s_mov_b64 s[20:21], s[86:87]
  buffer_load_dwordx4 v240, s[16:19], s39 offen lds
  buffer_load_dwordx4 v240, s[16:19], s41 offen offset:1024 lds
  s_mov_b64 s[24:25], s[88:89]
  buffer_load_dwordx4 v[136:139], v5, s[20:23], s42 offen
  buffer_load_dwordx4 v[140:143], v5, s[24:27], s42 offen
  v_mov_b32 v250, -1
  v_mov_b32 v251, -1
  v_mov_b32 v252, -1
  v_mov_b32 v253, -1
  s_mov_b64 s[44:45], s[92:93]
  s_load_dword s4, s[8:9], s6
  s_mov_b64 s[28:29], s[92:93]
  s_mov_b32 s41, s5
  v_mov_b32 v247, v6
  s_mov_b32 s30, 1409024
  s_mov_b32 s31, 0x20000
  s_mov_b64 exec, 0xffff
  buffer_load_dword v254, v247, s[28:31], s41 offen
  s_mov_b64 exec, -1
  s_lshr_b32 s58, s2, 5
  s_and_b32 s56, s2, 6
  s_lshl2_add_u32 s56, s56, s58
  s_bfe_u32 s58, s2, 0x20003
  s_and_b32 s57, s2, 1
  s_lshl2_add_u32 s57, s57, s58
  s_sub_u32 s12, s94, 1024
  s_subb_u32 s13, s95, 0
  s_mov_b64 s[52:53], s[96:97]
  s_mul_i32 s36, s34, 0x14100
  s_and_b32 s36, s36, 0x24300
  s_lshl_b32 s60, s56, 18
  s_add_u32 s60, s60, s36
  s_lshl_b32 s7, s34, 12
  s_add_u32 s7, s7, 65536
  s_xor_b32 s36, s56, s57
  s_and_b32 s36, s36, 3
  s_mul_i32 s36, s36, 0x280
  s_and_b32 s36, s36, 0x480
  s_xor_b32 s100, s60, s36
  s_mov_b32 s14, 8389632
  s_mov_b32 s15, 0x20000
  v_bfe_u32 v7, v1, 2, 2
  v_lshl_add_u32 v6, v3, 3, v7
  v_lshlrev_b32 v241, 12, v6
  v_sub_u32 v6, 0, v3
  v_xor_b32 v6, v6, v1
  v_and_b32 v6, 3, v6
  v_lshl_add_u32 v6, v6, 4, v241
  v_add_u32 v241, 1024, v6
  v_add_u32 v248, 64, v6
  s_mul_i32 s35, s3, 11
  s_lshr_b32 s36, s2, 4
  s_add_u32 s32, s35, s36
  s_lshl_b32 s37, s34, 12
  s_add_u32 s37, s37, 32768
  s_cmp_lt_u32 s2, 176
  s_cbranch_scc0 k_r1
  v_lshrrev_b32 v6, 1, v1
  v_lshrrev_b32 v7, 5, v1
  v_xor_b32 v10, v3, v1
  v_and_b32 v10, 1, v10
  v_lshlrev_b32 v10, 4, v10
  v_xor_b32 v11, v6, v7
  s_movk_i32 s6, 2752
  v_mad_u32_u24 v243, v11, s6, v10
  v_xor_b32 v11, 2, v11
  v_mad_u32_u24 v244, v11, s6, v10
  s_mul_i32 s5, s34, 352256
  s_lshl_b32 s36, s32, 5
  s_add_u32 s5, s5, s36
  s_mov_b32 s6, 88064
  s_branch k_r2
k_r1:
  s_mov_b64 s[44:45], s[98:99]
  s_sub_u32 s32, s2, 176
  s_cmp_lt_u32 s2, 220
  s_cselect_b32 s46, 704512, 0
  v_and_b32 v6, 32, v1
  v_lshl_add_u32 v243, v6, 4, v240
  v_mov_b32 v244, v243
  s_lshr_b32 s5, s32, 1
  s_lshl2_add_u32 s5, s5, s34
  s_lshl_b32 s5, s5, 13
  s_and_b32 s36, s32, 1
  s_lshl_b32 s36, s36, 9
  s_add_u32 s5, s5, s36
  s_movk_i32 s6, 2048
k_r2:
  s_add_u32 m0, s37, 0
  s_nop 0
  buffer_load_dwordx4 v243, s[44:47], s5 offen lds
  s_add_u32 m0, s37, 1024
  s_add_u32 s5, s5, s6
  buffer_load_dwordx4 v244, s[44:47], s5 offen lds
  s_add_u32 m0, s37, 2048
  s_add_u32 s5, s5, s6
  buffer_load_dwordx4 v243, s[44:47], s5 offen lds
  s_add_u32 m0, s37, 3072
  s_add_u32 s5, s5, s6
  buffer_load_dwordx4 v244, s[44:47], s5 offen lds
  v_cvt_f32_u32 v6, v2
  v_lshlrev_b32 v7, 2, v3
  v_cvt_f32_u32 v7, v7
  v_mul_f32 v8, 0x3d000000, v6
  v_mul_f32 v9, v7, v8
  v_fmamk_f32 v10, v8, 0x00000000, v9
  v_fmamk_f32 v11, v8, 0x3f800000, v9
  v_cos_f32 v12, v10
  v_cos_f32 v13, v11
  v_sin_f32 v14, v10
  v_sin_f32 v15, v11
  v_cvt_pk_bf16_f32 v16, v12, v13
  v_cvt_pk_bf16_f32 v24, -v14, -v15
  v_xor_b32 v20, 0x80000000, v16
  v_xor_b32 v28, 0x80000000, v24
  v_fmamk_f32 v10, v8, 0x40000000, v9
  v_fmamk_f32 v11, v8, 0x40400000, v9
  v_cos_f32 v12, v10
  v_cos_f32 v13, v11
  v_sin_f32 v14, v10
  v_sin_f32 v15, v11
  v_cvt_pk_bf16_f32 v17, v12, v13
  v_cvt_pk_bf16_f32 v25, -v14, -v15
  v_xor_b32 v21, 0x80000000, v17
  v_xor_b32 v29, 0x80000000, v25
  v_fmamk_f32 v10, v8, 0x41800000, v9
  v_fmamk_f32 v11, v8, 0x41880000, v9
  v_cos_f32 v12, v10
  v_cos_f32 v13, v11
  v_sin_f32 v14, v10
  v_sin_f32 v15, v11
  v_cvt_pk_bf16_f32 v18, v12, v13
  v_cvt_pk_bf16_f32 v26, -v14, -v15
  v_xor_b32 v22, 0x80000000, v18
  v_xor_b32 v30, 0x80000000, v26
  v_fmamk_f32 v10, v8, 0x41900000, v9
  v_fmamk_f32 v11, v8, 0x41980000, v9
  v_cos_f32 v12, v10
  v_cos_f32 v13, v11
  v_sin_f32 v14, v10
  v_sin_f32 v15, v11
  v_cvt_pk_bf16_f32 v19, v12, v13
  v_cvt_pk_bf16_f32 v27, -v14, -v15
  v_xor_b32 v23, 0x80000000, v19
  v_xor_b32 v31, 0x80000000, v27
  v_mul_f32 v8, 0x3b000000, v6
  v_mul_f32 v9, v7, v8
  v_cos_f32 v32, v9
  v_sin_f32 v40, v9
  v_add_f32 v9, v9, v8
  v_cos_f32 v33, v9
  v_sin_f32 v41, v9
  v_add_f32 v9, v9, v8
  v_cos_f32 v34, v9
  v_sin_f32 v42, v9
  v_add_f32 v9, v9, v8
  v_cos_f32 v35, v9
  v_sin_f32 v43, v9
  v_add_f32 v8, 0x3d000000, v8
  v_mul_f32 v9, v7, v8
  v_cos_f32 v36, v9
  v_sin_f32 v44, v9
  v_add_f32 v9, v9, v8
  v_cos_f32 v37, v9
  v_sin_f32 v45, v9
  v_add_f32 v9, v9, v8
  v_cos_f32 v38, v9
  v_sin_f32 v46, v9
  v_add_f32 v9, v9, v8
  v_cos_f32 v39, v9
  v_sin_f32 v47, v9
  v_lshrrev_b32 v8, 1, v2
  v_cvt_f32_u32 v8, v8
  v_mul_f32 v8, 0x3d800000, v8
  v_and_b32 v9, 1, v2
  v_cvt_f32_u32 v9, v9
  v_mul_f32 v9, 0x3e800000, v9
  v_fmac_f32 v9, v7, v8
  v_add_f32 v10, v9, v8
  v_cos_f32 v12, v9
  v_cos_f32 v13, v10
  v_sin_f32 v14, v9
  v_sin_f32 v15, v10
  v_cvt_pk_bf16_f32 v48, v12, v13
  v_cvt_pk_bf16_f32 v50, v14, v15
  v_add_f32 v9, v10, v8
  v_add_f32 v10, v9, v8
  v_cos_f32 v12, v9
  v_cos_f32 v13, v10
  v_sin_f32 v14, v9
  v_sin_f32 v15, v10
  v_cvt_pk_bf16_f32 v49, v12, v13
  v_cvt_pk_bf16_f32 v51, v14, v15
  v_mov_b32 v52, 0xbf803f80
  v_mov_b32 v53, 0xbf803f80
  v_mov_b32 v54, 0
  v_mov_b32 v55, 0
  s_lshl_b32 s35, s34, 4
  v_add_u32 v232, s35, v2
  v_cvt_f32_u32 v232, v232
  v_lshlrev_b32 v233, 2, v3
  v_cvt_f32_u32 v233, v233
  v_mul_u32_u24 v234, 18, v3
  v_and_b32 v234, 20, v234
  v_cvt_f32_u32 v234, v234
  v_lshrrev_b32 v235, 2, v2
  v_mul_u32_u24 v235, 18, v235
  v_and_b32 v235, 20, v235
  v_and_or_b32 v235, v2, 3, v235
  v_cvt_f32_u32 v235, v235
  v_mul_f32 v10, 0x3c800000, v232
  s_xor_b32 s36, s35, 0
  v_cvt_f32_u32 v12, s36
  v_add_f32 v12, v12, v233
  v_mul_f32 v12, v12, v10
  v_add_f32 v11, v12, v10
  v_cos_f32 v236, v12
  v_sin_f32 v237, v12
  v_cos_f32 v238, v11
  v_sin_f32_e64 v239, v11
  v_cvt_pk_bf16_f32 v168, v236, v237
  v_cvt_pk_bf16_f32 v176, -v237, v236
  v_cvt_pk_f16_f32 v152, v236, v237
  v_cvt_pk_f16_f32 v160, -v237, v236
  v_cvt_pk_bf16_f32 v169, v238, v239
  v_cvt_pk_bf16_f32 v177, -v239, v238
  v_cvt_pk_f16_f32 v153, v238, v239
  v_cvt_pk_f16_f32 v161, -v239, v238
  v_add_f32 v12, v11, v10
  v_add_f32 v11, v12, v10
  v_cos_f32 v236, v12
  v_sin_f32 v237, v12
  v_cos_f32 v238, v11
  v_sin_f32 v239, v11
  v_cvt_pk_bf16_f32 v170, v236, v237
  v_cvt_pk_bf16_f32 v178, -v237, v236
  v_cvt_pk_f16_f32 v154, v236, v237
  v_cvt_pk_f16_f32 v162, -v237, v236
  v_cvt_pk_bf16_f32 v171, v238, v239
  v_cvt_pk_bf16_f32 v179, -v239, v238
  v_cvt_pk_f16_f32 v155, v238, v239
  v_cvt_pk_f16_f32 v163, -v239, v238
  s_xor_b32 s36, s35, 16
  v_cvt_f32_u32 v12, s36
  v_add_f32 v12, v12, v233
  v_mul_f32 v12, v12, v10
  v_add_f32 v11, v12, v10
  v_cos_f32 v236, v12
  v_sin_f32 v237, v12
  v_cos_f32 v238, v11
  v_sin_f32_e64 v239, v11
  v_cvt_pk_bf16_f32 v172, v236, v237
  v_cvt_pk_bf16_f32 v180, -v237, v236
  v_cvt_pk_f16_f32 v156, v236, v237
  v_cvt_pk_f16_f32 v164, -v237, v236
  v_cvt_pk_bf16_f32 v173, v238, v239
  v_cvt_pk_bf16_f32 v181, -v239, v238
  v_cvt_pk_f16_f32 v157, v238, v239
  v_cvt_pk_f16_f32 v165, -v239, v238
  v_add_f32 v12, v11, v10
  v_add_f32 v11, v12, v10
  v_cos_f32 v236, v12
  v_sin_f32 v237, v12
  v_cos_f32 v238, v11
  v_sin_f32 v239, v11
  v_cvt_pk_bf16_f32 v174, v236, v237
  v_cvt_pk_bf16_f32 v182, -v237, v236
  v_cvt_pk_f16_f32 v158, v236, v237
  v_cvt_pk_f16_f32 v166, -v237, v236
  v_cvt_pk_bf16_f32 v175, v238, v239
  v_cvt_pk_bf16_f32 v183, -v239, v238
  v_cvt_pk_f16_f32 v159, v238, v239
  v_cvt_pk_f16_f32 v167, -v239, v238
  s_mov_b64 s[28:29], 1
  v_lshlrev_b32 v4, 3, v1
  v_lshl_add_u32 v4, s34, 11, v4
  v_mov_b32 v5, 0x3f803f80
  v_cmp_eq_u32 vcc, 0, v2
  v_mul_u32_u24 v6, 4224, v3
  v_lshl_add_u32 v6, v2, 6, v6
  v_and_b32 v7, 8, v2
  s_and_b32 s40, s34, 2
  s_add_u32 s40, s40, s34
  s_lshl_b32 s40, s40, 3
  v_lshlrev_b32 v7, 1, v7
  v_add3_u32 v6, v6, v7, s40
  v_and_b32 v7, 7, v1
  v_lshl_add_u32 v7, s34, 3, v7
  v_add_u32 v15, 1, v7
  v_and_b32 v15, 31, v15
  v_and_b32 v9, 4, v245
  v_add_lshl_u32 v9, v9, v245, 2
  s_movk_i32 s40, 528
  v_mad_u32_u24 v7, v7, s40, v9
  v_mad_u32_u24 v15, v15, s40, v9
  v_mov_b32 v64, 0xfffcfffc
  s_mov_b32 s30, 0x05040100
  s_mov_b32 s31, 0x07060302
  s_mul_i32 s40, s34, 0x12
  s_and_b32 s40, s40, 0x14
  v_lshrrev_b32 v8, 1, v1
  v_and_b32 v9, 32, v1
  v_add3_u32 v8, v8, v9, s40
  v_lshrrev_b32 v9, 1, v9
  v_sub_u32 v8, v8, v9
  v_add_u32 v65, v9, v240
  s_mul_i32 s40, s34, 4224
  v_add_u32 v65, s40, v65
  v_lshl_add_u32 v9, s34, 12, v240
  v_mov_b32 v14, 0xc2000000
  v_cndmask_b32 v14, 0, v14, vcc
  s_lshl_b32 s41, s2, 14
  s_lshl_b32 s39, s2, 7
  s_add_u32 s39, s39, 14909440
  s_cmp_eq_u32 s34, 0
  s_cselect_b32 s39, s39, s10
  s_waitcnt vmcnt(7)
  ds_read_b64_tr_b16 v[56:57], v4 offset:0
  ds_read_b64_tr_b16 v[58:59], v4 offset:512
  ds_read_b64_tr_b16 v[60:61], v4 offset:1024
  ds_read_b64_tr_b16 v[62:63], v4 offset:1536
  v_lshlrev_b32 v246, 9, v1
  v_and_b32 v246, 0x7c00, v246
  s_lshl_b32 s36, s58, 15
  s_add_u32 s59, s60, s36
  s_xor_b32 s59, s59, 0
  v_xor_b32 v246, s59, v246
  s_mov_b32 exec_lo, 0xaaaaaaaa
  s_mov_b32 exec_hi, 0xaaaaaaaa
  v_add_u32 v246, 128, v246
  s_mov_b32 exec_lo, -1
  s_mov_b32 exec_hi, 0
  buffer_load_dword v246, v246, s[12:15], 0 offen offset:1024
  s_mov_b64 exec, -1
  s_mov_b32 s54, 4096
  s_mov_b32 s55, 0x20000
  s_lshl_b32 s36, s56, 7
  s_mov_b64 exec, 1
  buffer_load_dword a253, v240, s[52:55], s36 offen
  s_mov_b64 exec, -1
  s_waitcnt lgkmcnt(0)
  s_add_u32 s4, s4, 0x9e3779b1
  s_lshl_b32 s26, s34, 2
  s_lshr_b32 s26, s4, s26
  s_lshr_b32 s27, s26, 2
  s_and_b32 s26, s26, 0x30003
  s_and_b32 s27, s27, 0x30003
  v_lshrrev_b32 v66, v8, s4
  v_dot2_f32_bf16 v10, v56, v5, 0
  v_dot2_f32_bf16 v12, v56, v56, 0
  v_dot2_f32_bf16 v11, v60, v5, 0
  v_dot2_f32_bf16 v13, v60, v60, 0
  v_dot2_f32_bf16 v10, v57, v5, v10
  v_dot2_f32_bf16 v12, v57, v57, v12
  v_dot2_f32_bf16 v11, v61, v5, v11
  v_dot2_f32_bf16 v13, v61, v61, v13
  v_dot2_f32_bf16 v10, v58, v5, v10
  v_dot2_f32_bf16 v12, v58, v58, v12
  v_dot2_f32_bf16 v11, v62, v5, v11
  v_dot2_f32_bf16 v13, v62, v62, v13
  v_dot2_f32_bf16 v10, v59, v5, v10
  v_dot2_f32_bf16 v12, v59, v59, v12
  v_dot2_f32_bf16 v11, v63, v5, v11
  v_dot2_f32_bf16 v13, v63, v63, v13
  v_mfma_f32_16x16x32_bf16 v[72:75], v[56:59], v[16:19], 0
  v_permlane32_swap_b32 v10, v12
  v_mfma_f32_16x16x32_bf16 v[76:79], v[56:59], v[20:23], 0
  v_permlane32_swap_b32 v11, v13
  v_mfma_f32_16x16x32_bf16 v[80:83], v[56:59], v[24:27], 0
  v_add_f32 v10, v10, v12
  v_mfma_f32_16x16x32_bf16 v[84:87], v[56:59], v[28:31], 0
  v_add_f32 v11, v11, v13
  v_mfma_f32_16x16x32_bf16 v[88:91], v[60:63], v[16:19], 0
  v_mfma_f32_16x16x32_bf16 v[92:95], v[60:63], v[20:23], 0
  v_permlane16_swap_b32 v10, v11
  v_mfma_f32_16x16x32_bf16 v[96:99], v[60:63], v[24:27], 0
  v_add_f32 v10, v10, v11
  v_mfma_f32_16x16x32_bf16 v[100:103], v[60:63], v[28:31], 0
  s_nop 0
  v_add_f32_dpp v10, v10, v10 row_ror:8 row_mask:0xf bank_mask:0xf
  s_nop 1
  v_add_f32_dpp v10, v10, v10 row_ror:4 row_mask:0xf bank_mask:0xf
  s_nop 1
  v_add_f32_dpp v10, v10, v10 row_ror:2 row_mask:0xf bank_mask:0xf
  s_nop 1
  v_add_f32_dpp v10, v10, v10 row_ror:1 row_mask:0xf bank_mask:0xf
  v_mul_f32 v10, 0x3b000000, v10
  v_mov_b32 v11, v10
  s_nop 1
  v_permlane32_swap_b32 v10, v11
  s_nop 0
  v_readlane_b32 s24, v10, 0
  v_readlane_b32 s25, v10, 16
  v_fma_f32 v11, -v10, v10, v11
  v_max_f32 v11, 0, v11
  v_add_f32 v11, 0x3727c5ac, v11
  v_rsq_f32 v12, v11
  v_sqrt_f32 v13, v11
  v_fmac_f32 v72, s24, v14
  v_fmac_f32 v73, s24, v14
  v_fmac_f32 v74, s24, v14
  v_fmac_f32 v75, s24, v14
  v_fmac_f32 v88, s25, v14
  v_fmac_f32 v89, s25, v14
  v_fmac_f32 v90, s25, v14
  v_fmac_f32 v91, s25, v14
  v_mul_f32 v12, 0x3d800000, v12
  v_bfi_b32 v13, 15, v66, v13
  s_mov_b32 exec_lo, 0
  v_mov_b32 v13, v10
  s_mov_b32 exec_lo, 0x10001
  s_mov_b32 exec_hi, 0x10001
  ds_write_b32 v8, v13 offset:25600
  s_mov_b64 exec, -1
  v_readlane_b32 s20, v12, 0
  v_readlane_b32 s22, v12, 16
  v_pk_mul_f32 v[104:105], v[72:73], v[32:33]
  v_pk_mul_f32 v[112:113], v[80:81], v[32:33]
  v_pk_mul_f32 v[106:107], v[74:75], v[34:35]
  v_pk_mul_f32 v[114:115], v[82:83], v[34:35]
  v_pk_mul_f32 v[108:109], v[76:77], v[36:37]
  v_pk_mul_f32 v[116:117], v[84:85], v[36:37]
  v_pk_mul_f32 v[110:111], v[78:79], v[38:39]
  v_pk_mul_f32 v[118:119], v[86:87], v[38:39]
  v_pk_fma_f32 v[104:105], v[80:81], v[40:41], v[104:105]
  v_pk_fma_f32 v[112:113], v[72:73], v[40:41], v[112:113] neg_lo:[1,0,0] neg_hi:[1,0,0]
  v_pk_fma_f32 v[106:107], v[82:83], v[42:43], v[106:107]
  v_pk_fma_f32 v[114:115], v[74:75], v[42:43], v[114:115] neg_lo:[1,0,0] neg_hi:[1,0,0]
  v_pk_fma_f32 v[108:109], v[84:85], v[44:45], v[108:109]
  v_pk_fma_f32 v[116:117], v[76:77], v[44:45], v[116:117] neg_lo:[1,0,0] neg_hi:[1,0,0]
  v_pk_fma_f32 v[110:111], v[86:87], v[46:47], v[110:111]
  v_pk_fma_f32 v[118:119], v[78:79], v[46:47], v[118:119] neg_lo:[1,0,0] neg_hi:[1,0,0]
  v_cvt_pk_bf16_f32 v120, v104, v105
  v_cvt_pk_bf16_f32 v122, v112, v113
  v_cvt_pk_bf16_f32 v121, v106, v107
  v_cvt_pk_bf16_f32 v123, v114, v115
  v_cvt_pk_bf16_f32 v124, v108, v109
  v_cvt_pk_bf16_f32 v126, v116, v117
  v_cvt_pk_bf16_f32 v125, v110, v111
  v_cvt_pk_bf16_f32 v127, v118, v119
  v_mfma_f32_16x16x32_bf16 v[72:75], v[48:51], v[120:123], 0
  s_nop 0
  s_nop 0
  v_mfma_f32_16x16x32_bf16 v[76:79], v[48:51], v[124:127], 0
  v_mfma_f32_16x16x32_bf16 v[80:83], v[52:55], v[120:123], 0
  v_pk_mul_f32 v[104:105], v[88:89], v[32:33]
  v_pk_mul_f32 v[112:113], v[96:97], v[32:33]
  v_pk_mul_f32 v[106:107], v[90:91], v[34:35]
  v_pk_mul_f32 v[114:115], v[98:99], v[34:35]
  v_pk_mul_f32 v[108:109], v[92:93], v[36:37]
  v_pk_mul_f32 v[116:117], v[100:101], v[36:37]
  v_pk_mul_f32 v[110:111], v[94:95], v[38:39]
  v_pk_mul_f32 v[118:119], v[102:103], v[38:39]
  v_pk_fma_f32 v[104:105], v[96:97], v[40:41], v[104:105]
  v_pk_fma_f32 v[112:113], v[88:89], v[40:41], v[112:113] neg_lo:[1,0,0] neg_hi:[1,0,0]
  v_pk_fma_f32 v[106:107], v[98:99], v[42:43], v[106:107]
  v_pk_fma_f32 v[114:115], v[90:91], v[42:43], v[114:115] neg_lo:[1,0,0] neg_hi:[1,0,0]
  v_pk_fma_f32 v[108:109], v[100:101], v[44:45], v[108:109]
  v_pk_fma_f32 v[116:117], v[92:93], v[44:45], v[116:117] neg_lo:[1,0,0] neg_hi:[1,0,0]
  v_pk_fma_f32 v[110:111], v[102:103], v[46:47], v[110:111]
  v_pk_fma_f32 v[118:119], v[94:95], v[46:47], v[118:119] neg_lo:[1,0,0] neg_hi:[1,0,0]
  v_cvt_pk_bf16_f32 v128, v104, v105
  v_cvt_pk_bf16_f32 v130, v112, v113
  v_cvt_pk_bf16_f32 v129, v106, v107
  v_cvt_pk_bf16_f32 v131, v114, v115
  v_cvt_pk_bf16_f32 v132, v108, v109
  v_cvt_pk_bf16_f32 v134, v116, v117
  v_cvt_pk_bf16_f32 v133, v110, v111
  v_cvt_pk_bf16_f32 v135, v118, v119
  v_mfma_f32_16x16x32_bf16 v[88:91], v[48:51], v[128:131], 0
  s_nop 0
  v_mfma_f32_16x16x32_bf16 v[92:95], v[48:51], v[132:135], 0
  v_mfma_f32_16x16x32_bf16 v[96:99], v[52:55], v[128:131], 0
  s_waitcnt vmcnt(7)
  v_perm_b32 v144, v140, v136, s30
  ds_write_b32 v7, v144 offset:8272
  v_perm_b32 v145, v140, v136, s31
  ds_write_b32 v7, v145 offset:8336
  v_perm_b32 v146, v141, v137, s30
  ds_write_b32 v7, v146 offset:8400
  v_perm_b32 v147, v141, v137, s31
  ds_write_b32 v7, v147 offset:8464
  v_perm_b32 v148, v142, v138, s30
  ds_write_b32 v7, v148 offset:8528
  v_perm_b32 v149, v142, v138, s31
  ds_write_b32 v7, v149 offset:8592
  v_perm_b32 v150, v143, v139, s30
  ds_write_b32 v7, v150 offset:8656
  v_perm_b32 v151, v143, v139, s31
  ds_write_b32 v15, v151 offset:8208
  v_mul_f32 v80, 0x3f3504f3, v80
  v_cndmask_b32 v72, v72, v80, s[28:29]
  v_cndmask_b32 v73, v73, 0, s[28:29]
  v_pk_mul_f32 v[72:73], v[72:73], s[20:21] op_sel_hi:[1,0]
  v_pk_mul_f32 v[74:75], v[74:75], s[20:21] op_sel_hi:[1,0]
  v_pk_mul_f32 v[76:77], v[76:77], s[20:21] op_sel_hi:[1,0]
  v_pk_mul_f32 v[78:79], v[78:79], s[20:21] op_sel_hi:[1,0]
  v_cvt_pk_f16_f32 v104, v72, v73
  v_cvt_pk_f16_f32 v106, v74, v75
  v_cvt_pk_f16_f32 v108, v76, v77
  v_cvt_pk_f16_f32 v110, v78, v79
  v_add_u32 v104, 0x20002, v104
  v_add_u32 v106, 0x20002, v106
  v_add_u32 v108, 0x20002, v108
  v_add_u32 v110, 0x20002, v110
  v_and_or_b32 v104, v104, v64, s26
  v_and_or_b32 v106, v106, v64, s26
  v_and_or_b32 v108, v108, v64, s26
  v_and_or_b32 v110, v110, v64, s26
  v_mul_f32 v96, 0x3f3504f3, v96
  v_cndmask_b32 v88, v88, v96, s[28:29]
  v_cndmask_b32 v89, v89, 0, s[28:29]
  v_pk_mul_f32 v[88:89], v[88:89], s[22:23] op_sel_hi:[1,0]
  v_pk_mul_f32 v[90:91], v[90:91], s[22:23] op_sel_hi:[1,0]
  v_pk_mul_f32 v[92:93], v[92:93], s[22:23] op_sel_hi:[1,0]
  v_pk_mul_f32 v[94:95], v[94:95], s[22:23] op_sel_hi:[1,0]
  v_cvt_pk_f16_f32 v105, v88, v89
  v_cvt_pk_f16_f32 v107, v90, v91
  v_cvt_pk_f16_f32 v109, v92, v93
  v_cvt_pk_f16_f32 v111, v94, v95
  v_add_u32 v105, 0x20002, v105
  v_add_u32 v107, 0x20002, v107
  v_add_u32 v109, 0x20002, v109
  v_add_u32 v111, 0x20002, v111
  v_and_or_b32 v105, v105, v64, s27
  v_and_or_b32 v107, v107, v64, s27
  v_and_or_b32 v109, v109, v64, s27
  v_and_or_b32 v111, v111, v64, s27
  ds_write_b64 v6, v[104:105] offset:8192
  ds_write_b64 v6, v[106:107] offset:10304
  ds_write_b64 v6, v[108:109] offset:9248
  ds_write_b64 v6, v[110:111] offset:11360
  s_waitcnt lgkmcnt(0)
  s_barrier
  ds_read_b128 v[120:123], v65 offset:8192
  ds_read_b128 v[124:127], v65 offset:9248
  ds_read_b128 v[128:131], v65 offset:10304
  ds_read_b128 v[132:135], v65 offset:11360
  ds_read_b128 v[136:139], v240 offset:25600
  s_waitcnt lgkmcnt(4)
  buffer_store_dwordx4 v[120:123], v9, s[8:11], s41 offen offset:0 sc1
  s_waitcnt lgkmcnt(3)
  buffer_store_dwordx4 v[124:127], v9, s[8:11], s41 offen offset:1024 sc1
  s_waitcnt lgkmcnt(2)
  buffer_store_dwordx4 v[128:131], v9, s[8:11], s41 offen offset:2048 sc1
  s_waitcnt lgkmcnt(1)
  buffer_store_dwordx4 v[132:135], v9, s[8:11], s41 offen offset:3072 sc1
  s_waitcnt lgkmcnt(0)
  s_mov_b64 exec, 0xff
  buffer_store_dwordx4 v[136:139], v240, s[8:11], s39 offen sc1
  s_mov_b64 exec, -1
  s_cmp_lt_u32 s2, 176
  s_cbranch_scc0 k_a1
  v_bfe_u32 v4, v1, 2, 2
  v_and_b32 v5, 3, v1
  v_lshrrev_b32 v8, 2, v1
  v_lshlrev_b32 v8, 4, v8
  v_lshl_add_u32 v8, v5, 2, v8
  v_add_u32 v8, v8, v4
  v_lshlrev_b32 v8, 5, v8
  v_lshrrev_b32 v5, 1, v5
  s_lshr_b32 s40, s34, 1
  v_xor_b32 v5, s40, v5
  v_lshl_add_u32 v8, v5, 4, v8
  s_and_b32 s40, s34, 1
  s_lshl_b32 s40, s40, 3
  s_add_u32 s40, s40, 32768
  v_add_u32 v8, s40, v8
  v_xor_b32 v9, 32, v8
  v_xor_b32 v10, 64, v8
  v_xor_b32 v11, 96, v8
  s_waitcnt vmcnt(7)
  s_barrier
  ds_read_b64_tr_b16 v[56:57], v8
  ds_read_b64_tr_b16 v[58:59], v8 offset:8192
  ds_read_b64_tr_b16 v[60:61], v9
  ds_read_b64_tr_b16 v[62:63], v9 offset:8192
  ds_read_b64_tr_b16 v[64:65], v10
  ds_read_b64_tr_b16 v[66:67], v10 offset:8192
  ds_read_b64_tr_b16 v[68:69], v11
  ds_read_b64_tr_b16 v[70:71], v11 offset:8192
  s_mov_b32 s20, 0x3d800000
  s_bitcmp1_b32 s2, 3
  s_cbranch_scc1 k_n1
  v_pk_mul_f32 v[32:33], v[32:33], s[20:21] op_sel_hi:[1,0]
  v_pk_mul_f32 v[34:35], v[34:35], s[20:21] op_sel_hi:[1,0]
  v_pk_mul_f32 v[40:41], v[40:41], s[20:21] op_sel_hi:[1,0]
  v_pk_mul_f32 v[42:43], v[42:43], s[20:21] op_sel_hi:[1,0]
  s_nop 0
  s_branch k_n2
k_n1:
  v_pk_mul_f32 v[32:33], v[36:37], s[20:21] op_sel_hi:[1,0]
  v_pk_mul_f32 v[34:35], v[38:39], s[20:21] op_sel_hi:[1,0]
  v_pk_mul_f32 v[40:41], v[44:45], s[20:21] op_sel_hi:[1,0]
  v_pk_mul_f32 v[42:43], v[46:47], s[20:21] op_sel_hi:[1,0]
  v_mov_b32 v16, v20
  v_mov_b32 v24, v28
  v_mov_b32 v17, v21
  v_mov_b32 v25, v29
  v_mov_b32 v18, v22
  v_mov_b32 v26, v30
  v_mov_b32 v19, v23
  v_mov_b32 v27, v31
  s_mov_b64 s[28:29], 0
  s_nop 0
k_n2:
  s_waitcnt lgkmcnt(6)
  v_mfma_f32_16x16x32_bf16 v[72:75], v[56:59], v[16:19], 0
  v_and_b32 v5, 1, v2
  v_lshl_add_u32 v4, v3, 1, v5
  v_mfma_f32_16x16x32_bf16 v[76:79], v[56:59], v[24:27], 0
  v_mul_u32_u24 v4, 1088, v4
  v_lshrrev_b32 v5, 2, v2
  s_waitcnt lgkmcnt(4)
  v_mfma_f32_16x16x32_bf16 v[80:83], v[60:63], v[16:19], 0
  v_mul_u32_u24 v5, 272, v5
  v_add_u32 v4, v4, v5
  v_mfma_f32_16x16x32_bf16 v[84:87], v[60:63], v[24:27], 0
  v_and_b32 v5, 2, v2
  v_lshl_add_u32 v4, v5, 1, v4
  s_waitcnt lgkmcnt(2)
  v_mfma_f32_16x16x32_bf16 v[88:91], v[64:67], v[16:19], 0
  v_lshl_add_u32 v4, s34, 6, v4
  v_lshl_add_u32 v6, s34, 12, v240
  v_mfma_f32_16x16x32_bf16 v[92:95], v[64:67], v[24:27], 0
  s_mul_i32 s40, s34, 2176
  v_lshl_add_u32 v7, v3, 4, v240
  s_waitcnt lgkmcnt(0)
  v_mfma_f32_16x16x32_bf16 v[96:99], v[68:71], v[16:19], 0
  v_add_u32 v7, s40, v7
  s_lshl_b32 s41, s32, 14
  v_mfma_f32_16x16x32_bf16 v[100:103], v[68:71], v[24:27], 0
  s_and_b32 s40, s2, 8
  s_lshl_b32 s40, s40, 8
  s_add_u32 s41, s41, s40
  s_add_u32 s16, s8, 11993088
  s_addc_u32 s17, s9, 0
  s_mov_b32 s18, 1409024
  s_mov_b32 s19, 0x20000
  v_pk_mul_f32 v[104:105], v[72:73], v[32:33] op_sel_hi:[1,0]
  v_pk_mul_f32 v[108:109], v[76:77], v[32:33] op_sel_hi:[1,0]
  v_pk_fma_f32 v[104:105], v[76:77], v[40:41], v[104:105] op_sel_hi:[1,0,1]
  v_pk_fma_f32 v[108:109], v[72:73], v[40:41], v[108:109] op_sel_hi:[1,0,1] neg_lo:[1,0,0] neg_hi:[1,0,0]
  v_pk_mul_f32 v[106:107], v[74:75], v[32:33] op_sel_hi:[1,0]
  v_pk_mul_f32 v[110:111], v[78:79], v[32:33] op_sel_hi:[1,0]
  v_pk_fma_f32 v[106:107], v[78:79], v[40:41], v[106:107] op_sel_hi:[1,0,1]
  v_pk_fma_f32 v[110:111], v[74:75], v[40:41], v[110:111] op_sel_hi:[1,0,1] neg_lo:[1,0,0] neg_hi:[1,0,0]
  v_pk_mul_f32 v[112:113], v[80:81], v[32:33] op_sel:[0,1] op_sel_hi:[1,1]
  v_pk_mul_f32 v[116:117], v[84:85], v[32:33] op_sel:[0,1] op_sel_hi:[1,1]
  v_pk_fma_f32 v[112:113], v[84:85], v[40:41], v[112:113] op_sel:[0,1,0] op_sel_hi:[1,1,1]
  v_pk_fma_f32 v[116:117], v[80:81], v[40:41], v[116:117] op_sel:[0,1,0] op_sel_hi:[1,1,1] neg_lo:[1,0,0] neg_hi:[1,0,0]
  v_pk_mul_f32 v[114:115], v[82:83], v[32:33] op_sel:[0,1] op_sel_hi:[1,1]
  v_pk_mul_f32 v[118:119], v[86:87], v[32:33] op_sel:[0,1] op_sel_hi:[1,1]
  v_pk_fma_f32 v[114:115], v[86:87], v[40:41], v[114:115] op_sel:[0,1,0] op_sel_hi:[1,1,1]
  v_pk_fma_f32 v[118:119], v[82:83], v[40:41], v[118:119] op_sel:[0,1,0] op_sel_hi:[1,1,1] neg_lo:[1,0,0] neg_hi:[1,0,0]
  v_pk_mul_f32 v[120:121], v[88:89], v[34:35] op_sel_hi:[1,0]
  v_pk_mul_f32 v[124:125], v[92:93], v[34:35] op_sel_hi:[1,0]
  v_pk_fma_f32 v[120:121], v[92:93], v[42:43], v[120:121] op_sel_hi:[1,0,1]
  v_pk_fma_f32 v[124:125], v[88:89], v[42:43], v[124:125] op_sel_hi:[1,0,1] neg_lo:[1,0,0] neg_hi:[1,0,0]
  v_pk_mul_f32 v[122:123], v[90:91], v[34:35] op_sel_hi:[1,0]
  v_pk_mul_f32 v[126:127], v[94:95], v[34:35] op_sel_hi:[1,0]
  v_pk_fma_f32 v[122:123], v[94:95], v[42:43], v[122:123] op_sel_hi:[1,0,1]
  v_pk_fma_f32 v[126:127], v[90:91], v[42:43], v[126:127] op_sel_hi:[1,0,1] neg_lo:[1,0,0] neg_hi:[1,0,0]
  v_pk_mul_f32 v[128:129], v[96:97], v[34:35] op_sel:[0,1] op_sel_hi:[1,1]
  v_pk_mul_f32 v[132:133], v[100:101], v[34:35] op_sel:[0,1] op_sel_hi:[1,1]
  v_pk_fma_f32 v[128:129], v[100:101], v[42:43], v[128:129] op_sel:[0,1,0] op_sel_hi:[1,1,1]
  v_pk_fma_f32 v[132:133], v[96:97], v[42:43], v[132:133] op_sel:[0,1,0] op_sel_hi:[1,1,1] neg_lo:[1,0,0] neg_hi:[1,0,0]
  v_pk_mul_f32 v[130:131], v[98:99], v[34:35] op_sel:[0,1] op_sel_hi:[1,1]
  v_pk_mul_f32 v[134:135], v[102:103], v[34:35] op_sel:[0,1] op_sel_hi:[1,1]
  v_pk_fma_f32 v[130:131], v[102:103], v[42:43], v[130:131] op_sel:[0,1,0] op_sel_hi:[1,1,1]
  v_pk_fma_f32 v[134:135], v[98:99], v[42:43], v[134:135] op_sel:[0,1,0] op_sel_hi:[1,1,1] neg_lo:[1,0,0] neg_hi:[1,0,0]
  v_cvt_pk_bf16_f32 v56, v104, v112
  v_cvt_pk_bf16_f32 v57, v120, v128
  v_cvt_pk_bf16_f32 v58, v108, v116
  v_cvt_pk_bf16_f32 v59, v124, v132
  v_cvt_pk_bf16_f32 v60, v105, v113
  v_cvt_pk_bf16_f32 v61, v121, v129
  v_mfma_f32_16x16x32_bf16 v[88:91], v[52:55], v[56:59], 0
  v_cvt_pk_bf16_f32 v62, v109, v117
  v_cvt_pk_bf16_f32 v63, v125, v133
  v_mfma_f32_16x16x32_bf16 v[72:75], v[48:51], v[56:59], 0
  v_cvt_pk_bf16_f32 v64, v106, v114
  v_cvt_pk_bf16_f32 v65, v122, v130
  v_mfma_f32_16x16x32_bf16 v[92:95], v[52:55], v[60:63], 0
  v_cvt_pk_bf16_f32 v66, v110, v118
  v_cvt_pk_bf16_f32 v67, v126, v134
  v_mfma_f32_16x16x32_bf16 v[76:79], v[48:51], v[60:63], 0
  v_cvt_pk_bf16_f32 v68, v107, v115
  v_cvt_pk_bf16_f32 v69, v123, v131
  v_mfma_f32_16x16x32_bf16 v[96:99], v[52:55], v[64:67], 0
  v_cvt_pk_bf16_f32 v70, v111, v119
  v_cvt_pk_bf16_f32 v71, v127, v135
  v_mfma_f32_16x16x32_bf16 v[80:83], v[48:51], v[64:67], 0
  s_nop 0
  s_nop 0
  v_mfma_f32_16x16x32_bf16 v[100:103], v[52:55], v[68:71], 0
  v_mfma_f32_16x16x32_bf16 v[84:87], v[48:51], v[68:71], 0
  v_mul_f32 v88, 0x3f3504f3, v88
  v_cndmask_b32 v72, v72, v88, s[28:29]
  v_cvt_pk_bf16_f32 v72, v72, v73
  ds_write_b32 v4, v72 offset:49152
  v_cvt_pk_bf16_f32 v74, v74, v75
  ds_write_b32 v4, v74 offset:49160
  v_mul_f32 v92, 0x3f3504f3, v92
  v_cndmask_b32 v76, v76, v92, s[28:29]
  v_cvt_pk_bf16_f32 v76, v76, v77
  ds_write_b32 v4, v76 offset:49168
  v_cvt_pk_bf16_f32 v78, v78, v79
  ds_write_b32 v4, v78 offset:49176
  v_mul_f32 v96, 0x3f3504f3, v96
  v_cndmask_b32 v80, v80, v96, s[28:29]
  v_cvt_pk_bf16_f32 v80, v80, v81
  ds_write_b32 v4, v80 offset:49184
  v_cvt_pk_bf16_f32 v82, v82, v83
  ds_write_b32 v4, v82 offset:49192
  v_mul_f32 v100, 0x3f3504f3, v100
  v_cndmask_b32 v84, v84, v100, s[28:29]
  v_cvt_pk_bf16_f32 v84, v84, v85
  ds_write_b32 v4, v84 offset:49200
  v_cvt_pk_bf16_f32 v86, v86, v87
  ds_write_b32 v4, v86 offset:49208
  s_waitcnt lgkmcnt(0)
  s_barrier
  ds_read_b128 v[120:123], v7 offset:49152
  ds_read_b128 v[124:127], v7 offset:50240
  s_waitcnt lgkmcnt(1)
  buffer_store_dwordx4 v[120:123], v6, s[16:19], s41 offen offset:0 sc1
  s_waitcnt lgkmcnt(0)
  buffer_store_dwordx4 v[124:127], v6, s[16:19], s41 offen offset:1024 sc1
  s_nop 0
  s_branch k_a9
k_a1:
  s_cmp_lt_u32 s2, 220
  s_cbranch_scc0 k_a2
  v_lshrrev_b32 v8, 2, v1
  v_lshlrev_b32 v8, 9, v8
  v_and_b32 v5, 3, v1
  v_lshl_add_u32 v8, v5, 4, v8
  v_lshl_add_u32 v8, s34, 7, v8
  s_and_b32 s40, s32, 1
  s_lshl2_add_u32 s40, s34, s40
  s_mul_i32 s40, s40, 45056
  s_lshr_b32 s41, s32, 1
  s_lshl_b32 s41, s41, 10
  s_add_u32 s41, s41, s40
  s_add_u32 s41, s41, 13926400
  s_waitcnt vmcnt(7)
  s_barrier
  ds_read_b64_tr_b16 v[104:105], v8 offset:32768
  ds_read_b64_tr_b16 v[106:107], v8 offset:40960
  ds_read_b64_tr_b16 v[108:109], v8 offset:32776
  ds_read_b64_tr_b16 v[110:111], v8 offset:40968
  ds_read_b64_tr_b16 v[112:113], v8 offset:32832
  ds_read_b64_tr_b16 v[114:115], v8 offset:41024
  ds_read_b64_tr_b16 v[116:117], v8 offset:32840
  ds_read_b64_tr_b16 v[118:119], v8 offset:41032
  s_add_u32 s40, s41, 0
  s_waitcnt lgkmcnt(6)
  buffer_store_dwordx4 v[104:107], v240, s[8:11], s40 offen sc1
  s_add_u32 s40, s41, 22528
  s_waitcnt lgkmcnt(4)
  buffer_store_dwordx4 v[108:111], v240, s[8:11], s40 offen sc1
  s_add_u32 s40, s41, 90112
  s_waitcnt lgkmcnt(2)
  buffer_store_dwordx4 v[112:115], v240, s[8:11], s40 offen sc1
  s_add_u32 s40, s41, 112640
  s_waitcnt lgkmcnt(0)
  buffer_store_dwordx4 v[116:119], v240, s[8:11], s40 offen sc1
  s_nop 0
  s_branch k_a9
k_a2:
  s_cmp_lt_u32 s2, 252
  s_cbranch_scc0 k_a9
  s_sub_u32 s35, s2, 220
  s_lshr_b32 s40, s35, 2
  s_lshl_b32 s40, s40, 5
  s_and_b32 s41, s35, 2
  s_lshl1_add_u32 s40, s41, s40
  v_and_b32 v4, 12, v2
  v_add3_u32 v4, v4, v2, s40
  v_cvt_f32_u32 v4, v4
  v_mul_f32 v4, 0x3b000000, v4
  s_and_b32 s41, s35, 1
  s_lshl_b32 s41, s41, 7
  s_and_b32 s42, s34, 2
  s_add_u32 s42, s42, s34
  s_lshl4_add_u32 s42, s42, s41
  v_lshl_add_u32 v5, v3, 2, s42
  v_cmp_eq_u32 vcc, 0, v5
  v_cvt_f32_u32 v5, v5
  v_mul_f32 v5, v5, v4
  s_lshl2_add_u32 s42, s35, s34
  s_lshl_b32 s42, s42, 11
  s_add_u32 s42, s42, 13402112
  v_mov_b32 v12, 0x3d800000
  v_mul_f32 v10, 0x43800000, v4
  v_mov_b32 v11, 0x3d3504f3
  v_cndmask_b32 v10, v5, v10, vcc
  v_cndmask_b32 v14, v12, v11, vcc
  v_cos_f32 v16, v10
  v_sin_f32 v17, v10
  v_fmamk_f32 v10, v4, 0x40000000, v5
  v_cos_f32 v18, v10
  v_sin_f32 v19, v10
  v_fmamk_f32 v10, v4, 0x42000000, v5
  v_cos_f32 v20, v10
  v_sin_f32 v21, v10
  v_fmamk_f32 v10, v4, 0x42080000, v5
  v_cos_f32 v22, v10
  v_sin_f32_e64 v23, v10
  v_pk_mul_f32 v[16:17], v[16:17], v[14:15] op_sel_hi:[1,0]
  v_pk_mul_f32 v[18:19], v[18:19], v[12:13] op_sel_hi:[1,0]
  v_pk_mul_f32 v[20:21], v[20:21], v[12:13] op_sel_hi:[1,0]
  v_pk_mul_f32 v[22:23], v[22:23], v[12:13] op_sel_hi:[1,0]
  v_cvt_pk_bf16_f32 v104, v16, -v17
  v_cvt_pk_bf16_f32 v105, v18, -v19
  v_cvt_pk_bf16_f32 v106, v20, -v21
  v_cvt_pk_bf16_f32 v107, v22, -v23
  buffer_store_dwordx4 v[104:107], v240, s[8:11], s42 offen offset:0 sc1
  v_fmamk_f32 v10, v4, 0x3f800000, v5
  v_cos_f32 v16, v10
  v_sin_f32 v17, v10
  v_fmamk_f32 v10, v4, 0x40400000, v5
  v_cos_f32 v18, v10
  v_sin_f32 v19, v10
  v_fmamk_f32 v10, v4, 0x42040000, v5
  v_cos_f32 v20, v10
  v_sin_f32 v21, v10
  v_fmamk_f32 v10, v4, 0x420c0000, v5
  v_cos_f32 v22, v10
  v_sin_f32 v23, v10
  v_pk_mul_f32 v[16:17], v[16:17], v[12:13] op_sel_hi:[1,0]
  v_pk_mul_f32 v[18:19], v[18:19], v[12:13] op_sel_hi:[1,0]
  v_pk_mul_f32 v[20:21], v[20:21], v[12:13] op_sel_hi:[1,0]
  v_pk_mul_f32 v[22:23], v[22:23], v[12:13] op_sel_hi:[1,0]
  v_cvt_pk_bf16_f32 v108, v16, -v17
  v_cvt_pk_bf16_f32 v109, v18, -v19
  v_cvt_pk_bf16_f32 v110, v20, -v21
  v_cvt_pk_bf16_f32 v111, v22, -v23
  buffer_store_dwordx4 v[108:111], v240, s[8:11], s42 offen offset:1024 sc1
  s_nop 1
k_a9:
  s_add_u32 m0, s7, 32768
  s_xor_b32 s59, s100, 16384
  buffer_load_dwordx4 v241, s[12:15], s59 offen offset:0 lds
  buffer_load_dwordx4 v248, s[12:15], s59 offen offset:1024 lds
  buffer_load_dwordx4 v241, s[12:15], s59 offen offset:2048 lds
  buffer_load_dwordx4 v248, s[12:15], s59 offen offset:3072 lds
  v_bfe_u32 v7, v1, 2, 2
  v_sub_u32 v6, 0, v7
  v_xor_b32 v6, v6, v3
  v_and_b32 v6, 3, v6
  v_lshl_add_u32 v6, v2, 2, v6
  v_lshl_add_u32 v242, v6, 4, s7
  s_lshl_b32 s3, s3, 5
  s_lshr_b32 s36, s2, 3
  s_add_u32 s3, s3, s36
  s_lshl_b32 s71, s34, 12
  s_add_u32 s71, s71, 139264
  s_lshl_b32 s41, s34, 14
  s_add_u32 s41, s41, s3
  s_lshl_b32 s41, s41, 6
  v_lshrrev_b32 v5, 2, v1
  v_lshlrev_b32 v5, 14, v5
  v_and_b32 v249, 2, v3
  v_xor_b32 v249, v249, v1
  v_and_b32 v249, 3, v249
  v_mul_u32_u24 v249, 0x28, v249
  v_and_or_b32 v5, v249, 0x30, v5
  s_sub_u32 s33, s32, 43
  s_cmp_lt_u32 s2, 176
  s_cselect_b32 s33, s33, 47
  s_bfe_u32 s36, s2, 0x10003
  s_lshl1_add_u32 s32, s33, s36
  s_lshl2_add_u32 s32, s32, s34
  s_lshl_b32 s32, s32, 6
  s_add_u32 s32, s32, 15437824
  s_cmp_lt_u32 s33, 43
  s_cselect_b32 s32, s32, s10
  v_mul_f32 v10, 0x3a000000, v232
  v_mul_f32 v11, v234, v10
  v_fmamk_f32 v12, v10, 0x00000000, v11
  v_cos_f32 v200, v12
  v_sin_f32 v208, v12
  v_fmamk_f32 v12, v10, 0x3f800000, v11
  v_cos_f32 v201, v12
  v_sin_f32 v209, v12
  v_fmamk_f32 v12, v10, 0x40000000, v11
  v_cos_f32 v202, v12
  v_sin_f32 v210, v12
  v_fmamk_f32 v12, v10, 0x40400000, v11
  v_cos_f32 v203, v12
  v_sin_f32 v211, v12
  v_fmamk_f32 v12, v10, 0x41000000, v11
  v_cos_f32 v204, v12
  v_sin_f32 v212, v12
  v_fmamk_f32 v12, v10, 0x41100000, v11
  v_cos_f32 v205, v12
  v_sin_f32 v213, v12
  v_fmamk_f32 v12, v10, 0x41200000, v11
  v_cos_f32 v206, v12
  v_sin_f32 v214, v12
  v_fmamk_f32 v12, v10, 0x41300000, v11
  v_cos_f32 v207, v12
  v_sin_f32 v215, v12
  v_mul_f32 v10, 0x3d000000, v235
  v_mul_f32 v11, v234, v10
  v_fmamk_f32 v236, v10, 0x00000000, v11
  v_fmamk_f32 v237, v10, 0x3f800000, v11
  v_cos_f32 v238, v236
  v_cos_f32 v239, v237
  v_sin_f32 v236, v236
  v_sin_f32 v237, v237
  v_cvt_pk_bf16_f32 v184, v238, v239
  v_cvt_pk_bf16_f32 v196, v236, v239
  v_cvt_pk_bf16_f32 v192, v236, v237
  v_cvt_pk_bf16_f32 v188, v238, -v237
  v_fmamk_f32 v236, v10, 0x40000000, v11
  v_fmamk_f32 v237, v10, 0x40400000, v11
  v_cos_f32 v238, v236
  v_cos_f32 v239, v237
  v_sin_f32 v236, v236
  v_sin_f32 v237, v237
  v_cvt_pk_bf16_f32 v185, v238, v239
  v_cvt_pk_bf16_f32 v197, -v236, -v239
  v_cvt_pk_bf16_f32 v193, v236, v237
  v_cvt_pk_bf16_f32 v189, -v238, v237
  v_fmamk_f32 v236, v10, 0x41000000, v11
  v_fmamk_f32 v237, v10, 0x41100000, v11
  v_cos_f32 v238, v236
  v_cos_f32 v239, v237
  v_sin_f32 v236, v236
  v_sin_f32 v237, v237
  v_cvt_pk_bf16_f32 v186, v238, v239
  v_cvt_pk_bf16_f32 v198, v236, v239
  v_cvt_pk_bf16_f32 v194, v236, v237
  v_cvt_pk_bf16_f32 v190, v238, -v237
  v_fmamk_f32 v236, v10, 0x41200000, v11
  v_fmamk_f32 v237, v10, 0x41300000, v11
  v_cos_f32 v238, v236
  v_cos_f32 v239, v237
  v_sin_f32 v236, v236
  v_sin_f32 v237, v237
  v_cvt_pk_bf16_f32 v187, v238, v239
  v_cvt_pk_bf16_f32 v199, -v236, -v239
  v_cvt_pk_bf16_f32 v195, v236, v237
  v_cvt_pk_bf16_f32 v191, -v238, v237
  s_waitcnt vmcnt(4)
  v_mov_b32 v14, 0
  v_mov_b32 v15, s4
  s_mov_b64 exec, 1
  buffer_store_dword v15, v14, s[8:11], s32 offen sc1
  s_mov_b64 exec, -1
  s_add_u32 m0, s71, 0
  s_add_u32 s42, s41, 0
  buffer_load_dwordx4 v5, s[8:11], s42 offen sc1 lds
  s_add_u32 m0, s71, 1024
  s_add_u32 s42, s41, 262144
  buffer_load_dwordx4 v5, s[8:11], s42 offen sc1 lds
  s_add_u32 m0, s71, 2048
  s_add_u32 s42, s41, 524288
  buffer_load_dwordx4 v5, s[8:11], s42 offen sc1 lds
  s_add_u32 m0, s71, 3072
  s_add_u32 s42, s41, 786432
  buffer_load_dwordx4 v5, s[8:11], s42 offen sc1 lds
  s_lshr_b32 s38, s34, 1
  s_lshl1_add_u32 s38, s56, s38
  s_lshl_b32 s39, s38, 12
  s_add_u32 s39, s39, 14647296
  s_and_b32 s40, s34, 1
  s_lshl1_add_u32 s36, s57, s40
  s_lshl_b32 s36, s36, 8
  s_add_u32 s36, s36, s39
  v_lshlrev_b32 v4, 2, v1
  buffer_store_dword v250, v4, s[8:11], s36 offen sc1
  s_add_u32 m0, s7, 49152
  s_xor_b32 s59, s100, 131072
  buffer_load_dwordx4 v241, s[12:15], s59 offen offset:0 lds
  buffer_load_dwordx4 v248, s[12:15], s59 offen offset:1024 lds
  buffer_load_dwordx4 v241, s[12:15], s59 offen offset:2048 lds
  buffer_load_dwordx4 v248, s[12:15], s59 offen offset:3072 lds
  s_lshl_b32 s61, s34, 13
  s_add_u32 s61, s61, 14909440
  s_lshl_b32 s70, s34, 11
  s_add_u32 s70, s70, 155648
  v_lshrrev_b32 v249, 1, v1
  v_mul_u32_u24 v249, 96, v249
  v_add_u32 v249, v249, v240
  s_lshl_b32 s35, s34, 4
  v_cvt_f32_u32 v11, s35
  v_add_f32 v11, v11, v233
  v_mul_f32 v10, 0x3a000000, v235
  v_mul_f32 v12, v11, v10
  v_cos_f32 v216, v12
  v_sin_f32 v224, v12
  v_add_f32 v12, v12, v10
  v_cos_f32 v217, v12
  v_sin_f32 v225, v12
  v_add_f32 v12, v12, v10
  v_cos_f32 v218, v12
  v_sin_f32 v226, v12
  v_add_f32 v12, v12, v10
  v_cos_f32 v219, v12
  v_sin_f32 v227, v12
  v_add_f32 v10, 0x3b800000, v10
  v_mul_f32 v12, v11, v10
  v_cos_f32 v220, v12
  v_sin_f32 v228, v12
  v_add_f32 v12, v12, v10
  v_cos_f32 v221, v12
  v_sin_f32 v229, v12
  v_add_f32 v12, v12, v10
  v_cos_f32 v222, v12
  v_sin_f32 v230, v12
  v_add_f32 v12, v12, v10
  v_cos_f32 v223, v12
  v_sin_f32 v231, v12
  v_bfe_i32 v10, v2, 0, 1
  v_and_b32 v10, 0x80008000, v10
  v_lshlrev_b32 v11, 2, v3
  v_sub_u32 v11, v2, v11
  v_mov_b32 v13, 0x3c00
  v_cmp_eq_u32 s[62:63], 0, v11
  v_cmp_eq_u32 s[64:65], 1, v11
  v_cmp_eq_u32 s[66:67], 2, v11
  v_cmp_eq_u32 s[68:69], 3, v11
  v_xor_b32 v16, v10, v152
  v_xor_b32 v17, v10, v153
  v_xor_b32 v18, v10, v154
  v_xor_b32 v19, v10, v155
  v_xor_b32 v20, v10, v156
  v_xor_b32 v21, v10, v157
  v_xor_b32 v22, v10, v158
  v_xor_b32 v23, v10, v159
  v_xor_b32 v24, v10, v160
  v_xor_b32 v25, v10, v161
  v_xor_b32 v26, v10, v162
  v_xor_b32 v27, v10, v163
  v_xor_b32 v28, v10, v164
  v_xor_b32 v29, v10, v165
  v_xor_b32 v30, v10, v166
  v_xor_b32 v31, v10, v167
  v_cndmask_b32 v56, 0, v13, s[62:63]
  v_cndmask_b32 v57, 0, v13, s[64:65]
  v_cndmask_b32 v58, 0, v13, s[66:67]
  v_cndmask_b32 v59, 0, v13, s[68:69]
  v_lshlrev_b32 v60, 16, v56
  v_lshlrev_b32 v61, 16, v57
  v_lshlrev_b32 v62, 16, v58
  v_lshlrev_b32 v63, 16, v59
  v_xor_b32 v32, v10, v168
  v_xor_b32 v33, v10, v169
  v_xor_b32 v34, v10, v170
  v_xor_b32 v35, v10, v171
  v_xor_b32 v36, v10, v172
  v_xor_b32 v37, v10, v173
  v_xor_b32 v38, v10, v174
  v_xor_b32 v39, v10, v175
  v_xor_b32 v40, v10, v176
  v_xor_b32 v41, v10, v177
  v_xor_b32 v42, v10, v178
  v_xor_b32 v43, v10, v179
  v_xor_b32 v44, v10, v180
  v_xor_b32 v45, v10, v181
  v_xor_b32 v46, v10, v182
  v_xor_b32 v47, v10, v183
  v_xor_b32 v48, 0x80008000, v192
  v_xor_b32 v49, 0x80008000, v193
  v_xor_b32 v50, 0x80008000, v194
  v_xor_b32 v51, 0x80008000, v195
  v_xor_b32 v52, 0x80008000, v196
  v_xor_b32 v53, 0x80008000, v197
  v_xor_b32 v54, 0x80008000, v198
  v_xor_b32 v55, 0x80008000, v199
  v_bfe_u32 v6, v2, 2, 1
  v_mul_u32_u24 v6, 544, v6
  v_lshl_add_u32 v6, v3, 10, v6
  v_lshrrev_b32 v7, 3, v2
  v_lshl_add_u32 v6, v7, 7, v6
  v_and_b32 v8, 2, v2
  v_lshl_add_u32 v6, v8, 5, v6
  v_and_b32_e64 v8, 1, v2
  v_lshl_add_u32 v6, v8, 4, v6
  v_lshl_add_u32 v232, s34, 12, v6
  v_lshl_add_u32 v236, s34, 11, v240
  v_xor_b32 v233, 4096, v232
  v_xor_b32 v237, 2048, v236
  v_xor_b32 v234, 8192, v232
  v_xor_b32 v238, 4096, v236
  v_xor_b32 v235, 12288, v232
  v_xor_b32 v239, 6144, v236
  v_add_u32 v232, 139264, v232
  v_add_u32 v236, 131072, v236
  v_add_u32 v233, 139264, v233
  v_add_u32 v237, 131072, v237
  v_add_u32 v234, 139264, v234
  v_add_u32 v238, 131072, v238
  v_add_u32 v235, 139264, v235
  v_add_u32 v239, 131072, v239
  v_xor_b32 v7, 1, v7
  v_lshlrev_b32 v7, 5, v7
  v_lshl_add_u32 v7, v2, 6, v7
  v_mul_u32_u24 v8, 10, v3
  v_and_b32 v8, 12, v8
  v_add_u32 v8, s34, v8
  v_lshl_add_u32 v7, v8, 10, v7
  v_add_u32 v7, 139264, v7
  v_mul_u32_u24 v8, 9, v3
  v_and_b32 v8, 10, v8
  v_and_b32 v9, 12, v2
  v_lshl_add_u32 v8, v9, 2, v8
  v_lshl_add_u32 v8, v8, 5, s70
  v_and_b32 v9, 3, v2
  v_lshl_add_u32 v8, v9, 3, v8
  v_lshrrev_b32 v9, 1, v2
  v_mul_u32_u24 v9, 65408, v9
  v_lshl_add_u32 v9, v2, 6, v9
  v_lshl_add_u32 v9, v3, 4, v9
  v_lshrrev_b32 v10, 3, v1
  v_min_u32 v10, 5, v10
  s_mul_i32 s98, s57, 3
  s_lshr_b32 s36, s57, 2
  s_sub_u32 s98, s98, s36
  s_cmp_eq_u32 s57, 3
  s_cselect_b32 s99, 22, 43
  s_sub_u32 s36, s99, 1
  v_lshl_add_u32 v10, s98, 1, v10
  v_min_u32 v10, s36, v10
  v_and_b32 v11, 7, v1
  v_lshl_add_u32 v10, v10, 3, v11
  v_lshlrev_b32 v10, 6, v10
  s_mov_b32 s5, 15437824
  s_cmp_eq_u32 s3, 0
  s_cselect_b32 s44, 0, 0xba000000
  s_mov_b32 s40, 0x3a000000
  s_bfe_u32 s36, s2, 0x30004
  s_and_b32 s37, s2, 1
  s_lshl3_add_u32 s36, s37, s36
  s_and_b32 s37, s2, 8
  s_lshl1_add_u32 s36, s37, s36
  s_and_b32 s37, s2, 128
  s_lshr_b32 s37, s37, 2
  s_add_u32 s36, s36, s37
  s_and_b32 s3, s3, 0xc0
  s_add_u32 s3, s3, s36
  s_lshl_b32 s37, s34, 11
  s_add_u32 s37, s37, s3
  s_lshl_b32 s37, s37, 8
  s_add_u32 s37, s37, 4194304
  s_lshl_b32 s39, s34, 8
  s_add_u32 s39, s39, s3
  s_lshl_b32 s39, s39, 6
  s_add_u32 s39, s39, 15110144
  s_add_u32 s20, s8, 12697600
  s_addc_u32 s21, s9, 0
  s_mov_b32 s22, 0
  s_mov_b32 s23, 0x20000
  s_lshl_b32 s22, s99, 14
  s_lshl_b32 s46, s98, 15
  s_lshl_b32 s47, s34, 12
  s_add_u32 s46, s46, s47
  v_and_b32 v250, 1, v2
  v_lshlrev_b32 v250, 3, v250
  v_lshrrev_b32 v250, v250, s4
  v_lshrrev_b32 v251, 2, v250
  v_lshrrev_b32 v252, 4, v250
  v_lshrrev_b32 v253, 6, v250
  v_and_b32 v254, 3, v2
  v_lshlrev_b32 v254, 3, v254
  v_lshrrev_b32 v254, v254, s4
  v_lshrrev_b32 v255, 4, v254
  s_waitcnt vmcnt(5)
  ds_read_b128 v[64:67], v232 offset:0
  ds_read_b128 v[68:71], v232 offset:256
  s_waitcnt lgkmcnt(0)
  v_xor_b32 v12, v64, v250
  v_bitop3_b32 v12, v65, v251, v12 bitop3:0xbe
  v_bitop3_b32 v12, v66, v252, v12 bitop3:0xbe
  v_bitop3_b32 v12, v67, v253, v12 bitop3:0xbe
  v_bitop3_b32 v12, v68, v250, v12 bitop3:0xbe
  v_bitop3_b32 v12, v69, v251, v12 bitop3:0xbe
  v_bitop3_b32 v12, v70, v252, v12 bitop3:0xbe
  v_bitop3_b32 v12, v71, v253, v12 bitop3:0xbe
  v_and_b32 v12, 0x30003, v12
  v_cmp_ne_u32 vcc, 0, v12
  s_nop 3
  s_cbranch_vccnz g_slow
g_ok:
  s_barrier
  ds_read_b128 v[72:75], v233 offset:0
  ds_read_b128 v[76:79], v233 offset:256
  ds_read_b128 v[80:83], v234 offset:0
  ds_read_b128 v[84:87], v234 offset:256
  ds_read_b128 v[88:91], v235 offset:0
  ds_read_b128 v[92:95], v235 offset:256
  ds_read_b128 v[96:99], v7
  ds_read_b128 v[100:103], v7 offset:16
  buffer_load_dword v11, v10, s[8:11], s5 offen sc1
  s_mov_b32 m0, s70
  s_add_u32 s42, s61, 3072
  buffer_load_dwordx4 v249, s[8:11], s61 offen sc1 lds
  buffer_load_dwordx4 v249, s[8:11], s42 offen offset:1024 sc1 lds
  v_and_b32 v64, 0xfffcfffc, v64
  v_and_b32 v65, 0xfffcfffc, v65
  v_and_b32 v66, 0xfffcfffc, v66
  v_and_b32 v67, 0xfffcfffc, v67
  v_and_b32 v68, 0xfffcfffc, v68
  v_and_b32 v69, 0xfffcfffc, v69
  v_and_b32 v70, 0xfffcfffc, v70
  v_and_b32 v71, 0xfffcfffc, v71
  v_mfma_f32_16x16x32_f16 v[112:115], v[64:67], v[56:59], 0
  v_mfma_f32_16x16x32_f16 v[120:123], v[64:67], v[60:63], 0
  v_mfma_f32_16x16x32_f16 v[116:119], v[68:71], v[56:59], 0
  v_mfma_f32_16x16x32_f16 v[124:127], v[68:71], v[60:63], 0
  v_mfma_f32_16x16x32_f16 v[128:131], v[64:67], v[152:155], 0
  s_waitcnt lgkmcnt(7)
  v_and_b32 v72, 0xfffcfffc, v72
  v_and_b32 v73, 0xfffcfffc, v73
  v_mfma_f32_16x16x32_f16 v[136:139], v[64:67], v[160:163], 0
  v_and_b32 v74, 0xfffcfffc, v74
  v_and_b32 v75, 0xfffcfffc, v75
  v_mfma_f32_16x16x32_f16 v[132:135], v[68:71], v[152:155], 0
  s_waitcnt lgkmcnt(6)
  v_and_b32 v76, 0xfffcfffc, v76
  v_and_b32 v77, 0xfffcfffc, v77
  v_mfma_f32_16x16x32_f16 v[140:143], v[68:71], v[160:163], 0
  v_and_b32 v78, 0xfffcfffc, v78
  v_and_b32 v79, 0xfffcfffc, v79
  v_mfma_f32_16x16x32_f16 v[128:131], v[72:75], v[156:159], v[128:131]
  s_waitcnt lgkmcnt(5)
  v_and_b32 v80, 0xfffcfffc, v80
  v_and_b32 v81, 0xfffcfffc, v81
  v_mfma_f32_16x16x32_f16 v[136:139], v[72:75], v[164:167], v[136:139]
  v_and_b32 v82, 0xfffcfffc, v82
  v_and_b32 v83, 0xfffcfffc, v83
  v_mfma_f32_16x16x32_f16 v[132:135], v[76:79], v[156:159], v[132:135]
  s_waitcnt lgkmcnt(4)
  v_and_b32 v84, 0xfffcfffc, v84
  v_and_b32 v85, 0xfffcfffc, v85
  v_mfma_f32_16x16x32_f16 v[140:143], v[76:79], v[164:167], v[140:143]
  v_and_b32 v86, 0xfffcfffc, v86
  v_and_b32 v87, 0xfffcfffc, v87
  v_mfma_f32_16x16x32_f16 v[128:131], v[80:83], v[16:19], v[128:131]
  s_waitcnt lgkmcnt(3)
  v_and_b32 v88, 0xfffcfffc, v88
  v_and_b32 v89, 0xfffcfffc, v89
  v_mfma_f32_16x16x32_f16 v[136:139], v[80:83], v[24:27], v[136:139]
  v_and_b32 v90, 0xfffcfffc, v90
  v_and_b32 v91, 0xfffcfffc, v91
  v_mfma_f32_16x16x32_f16 v[132:135], v[84:87], v[16:19], v[132:135]
  s_waitcnt lgkmcnt(2)
  v_and_b32 v92, 0xfffcfffc, v92
  v_and_b32 v93, 0xfffcfffc, v93
  v_mfma_f32_16x16x32_f16 v[140:143], v[84:87], v[24:27], v[140:143]
  v_and_b32 v94, 0xfffcfffc, v94
  v_and_b32 v95, 0xfffcfffc, v95
  v_mfma_f32_16x16x32_f16 v[128:131], v[88:91], v[20:23], v[128:131]
  v_mfma_f32_16x16x32_f16 v[136:139], v[88:91], v[28:31], v[136:139]
  v_mfma_f32_16x16x32_f16 v[132:135], v[92:95], v[20:23], v[132:135]
  v_mfma_f32_16x16x32_f16 v[140:143], v[92:95], v[28:31], v[140:143]
  s_waitcnt vmcnt(2)
  v_cmp_ne_u32 vcc, s4, v11
  s_nop 4
  s_cbranch_vccz w2_go
  s_mov_b32 s43, 0
w2_poll:
  buffer_load_dword v11, v10, s[8:11], s5 offen sc1
  s_add_u32 s43, s43, 1
  s_waitcnt vmcnt(0)
  v_cmp_ne_u32 vcc, s4, v11
  s_cmp_ge_u32 s43, 100000
  s_nop 2
  s_cbranch_scc1 w2_go
  s_cbranch_vccnz w2_poll
w2_go:
  s_waitcnt lgkmcnt(0)
  s_add_u32 m0, s47, 0
  s_add_u32 s59, s46, 0
  v_lshlrev_b32 v16, 16, v96
  v_and_b32 v24, 0xffff0000, v96
  buffer_load_dwordx4 v240, s[20:23], s59 offen offset:0 sc1 lds
  v_lshlrev_b32 v17, 16, v97
  v_and_b32 v25, 0xffff0000, v97
  v_lshlrev_b32 v18, 16, v98
  v_and_b32 v26, 0xffff0000, v98
  v_pk_mul_f32 v[152:153], v[128:129], v[200:201]
  v_pk_mul_f32 v[160:161], v[136:137], v[200:201]
  v_pk_mul_f32 v[154:155], v[130:131], v[202:203]
  v_pk_mul_f32 v[162:163], v[138:139], v[202:203]
  v_pk_mul_f32 v[156:157], v[132:133], v[204:205]
  v_pk_mul_f32 v[164:165], v[140:141], v[204:205]
  v_pk_mul_f32 v[158:159], v[134:135], v[206:207]
  v_pk_mul_f32 v[166:167], v[142:143], v[206:207]
  v_pk_fma_f32 v[152:153], v[136:137], v[208:209], v[152:153]
  v_pk_fma_f32 v[160:161], v[128:129], v[208:209], v[160:161] neg_lo:[1,0,0] neg_hi:[1,0,0]
  v_pk_fma_f32 v[154:155], v[138:139], v[210:211], v[154:155]
  v_pk_fma_f32 v[162:163], v[130:131], v[210:211], v[162:163] neg_lo:[1,0,0] neg_hi:[1,0,0]
  v_pk_fma_f32 v[156:157], v[140:141], v[212:213], v[156:157]
  buffer_load_dwordx4 v240, s[20:23], s59 offen offset:1024 sc1 lds
  v_pk_fma_f32 v[164:165], v[132:133], v[212:213], v[164:165] neg_lo:[1,0,0] neg_hi:[1,0,0]
  v_pk_fma_f32 v[158:159], v[142:143], v[214:215], v[158:159]
  v_pk_fma_f32 v[166:167], v[134:135], v[214:215], v[166:167] neg_lo:[1,0,0] neg_hi:[1,0,0]
  v_cvt_pk_bf16_f32 v144, v152, v153
  v_cvt_pk_bf16_f32 v145, v154, v155
  v_cvt_pk_bf16_f32 v146, v156, v157
  v_cvt_pk_bf16_f32 v147, v158, v159
  v_cvt_pk_bf16_f32 v148, v160, v161
  v_cvt_pk_bf16_f32 v149, v162, v163
  v_cvt_pk_bf16_f32 v150, v164, v165
  v_cvt_pk_bf16_f32 v151, v166, v167
  v_mfma_f32_16x16x32_bf16 v[128:131], v[184:187], v[144:147], 0
  v_mfma_f32_16x16x32_bf16 v[136:139], v[48:51], v[144:147], 0
  buffer_load_dwordx4 v240, s[20:23], s59 offen offset:2048 sc1 lds
  v_mfma_f32_16x16x32_bf16 v[132:135], v[188:191], v[144:147], 0
  v_mfma_f32_16x16x32_bf16 v[140:143], v[52:55], v[144:147], 0
  v_mfma_f32_16x16x32_bf16 v[128:131], v[192:195], v[148:151], v[128:131]
  v_mfma_f32_16x16x32_bf16 v[136:139], v[184:187], v[148:151], v[136:139]
  v_mfma_f32_16x16x32_bf16 v[132:135], v[196:199], v[148:151], v[132:135]
  v_mfma_f32_16x16x32_bf16 v[140:143], v[188:191], v[148:151], v[140:143]
  buffer_load_dwordx4 v240, s[20:23], s59 offen offset:3072 sc1 lds
  v_lshlrev_b32 v19, 16, v99
  v_and_b32 v27, 0xffff0000, v99
  v_lshlrev_b32 v20, 16, v100
  v_and_b32 v28, 0xffff0000, v100
  v_lshlrev_b32 v21, 16, v101
  v_and_b32 v29, 0xffff0000, v101
  v_lshlrev_b32 v22, 16, v102
  v_and_b32 v30, 0xffff0000, v102
  v_lshlrev_b32_e64 v23, 16, v103
  v_and_b32 v31, 0xffff0000, v103
  v_pk_mul_f32 v[152:153], v[128:129], v[16:17]
  s_add_u32 m0, s47, 49152
  s_add_u32 s59, s46, 49152
  v_pk_mul_f32 v[160:161], v[136:137], v[16:17]
  v_pk_mul_f32 v[154:155], v[130:131], v[18:19]
  v_pk_mul_f32 v[162:163], v[138:139], v[18:19]
  v_pk_mul_f32 v[156:157], v[132:133], v[20:21]
  buffer_load_dwordx4 v240, s[20:23], s59 offen offset:0 sc1 lds
  v_pk_mul_f32 v[164:165], v[140:141], v[20:21]
  v_pk_mul_f32 v[158:159], v[134:135], v[22:23]
  v_pk_mul_f32 v[166:167], v[142:143], v[22:23]
  v_pk_fma_f32 v[152:153], v[136:137], v[24:25], v[152:153] neg_lo:[1,0,0] neg_hi:[1,0,0]
  v_pk_fma_f32 v[160:161], v[128:129], v[24:25], v[160:161]
  v_pk_fma_f32 v[154:155], v[138:139], v[26:27], v[154:155] neg_lo:[1,0,0] neg_hi:[1,0,0]
  v_pk_fma_f32 v[162:163], v[130:131], v[26:27], v[162:163]
  v_pk_fma_f32 v[156:157], v[140:141], v[28:29], v[156:157] neg_lo:[1,0,0] neg_hi:[1,0,0]
  v_pk_fma_f32 v[164:165], v[132:133], v[28:29], v[164:165]
  v_pk_fma_f32 v[158:159], v[142:143], v[30:31], v[158:159] neg_lo:[1,0,0] neg_hi:[1,0,0]
  v_pk_fma_f32 v[166:167], v[134:135], v[30:31], v[166:167]
  v_cvt_pk_bf16_f32 v144, v152, v153
  v_cvt_pk_bf16_f32 v145, v154, v155
  v_cvt_pk_bf16_f32 v146, v156, v157
  v_cvt_pk_bf16_f32 v147, v158, v159
  v_cvt_pk_bf16_f32 v148, v160, v161
  v_cvt_pk_bf16_f32 v149, v162, v163
  buffer_load_dwordx4 v240, s[20:23], s59 offen offset:1024 sc1 lds
  v_cvt_pk_bf16_f32 v150, v164, v165
  v_cvt_pk_bf16_f32 v151, v166, v167
  v_mfma_f32_16x16x32_bf16 v[128:131], v[144:147], v[184:187], 0
  v_mfma_f32_16x16x32_bf16 v[136:139], v[144:147], v[192:195], 0
  v_mfma_f32_16x16x32_bf16 v[132:135], v[144:147], v[188:191], 0
  v_mfma_f32_16x16x32_bf16 v[140:143], v[144:147], v[196:199], 0
  buffer_load_dwordx4 v240, s[20:23], s59 offen offset:2048 sc1 lds
  v_mfma_f32_16x16x32_bf16 v[128:131], v[148:151], v[48:51], v[128:131]
  v_mfma_f32_16x16x32_bf16 v[136:139], v[148:151], v[184:187], v[136:139]
  v_mfma_f32_16x16x32_bf16 v[132:135], v[148:151], v[52:55], v[132:135]
  v_mfma_f32_16x16x32_bf16 v[140:143], v[148:151], v[188:191], v[140:143]
  s_waitcnt vmcnt(7)
  s_nop 0
  buffer_load_dwordx4 v240, s[20:23], s59 offen offset:3072 sc1 lds
  ds_read_b64 v[104:105], v8 offset:0
  ds_read_b64 v[106:107], v8 offset:32
  ds_read_b64 v[108:109], v8 offset:128
  ds_read_b64 v[110:111], v8 offset:160
  v_pk_mul_f32 v[152:153], v[128:129], v[216:217]
  v_pk_mul_f32 v[160:161], v[136:137], v[216:217]
  v_pk_mul_f32 v[154:155], v[130:131], v[218:219]
  v_pk_mul_f32 v[162:163], v[138:139], v[218:219]
  v_pk_mul_f32 v[156:157], v[132:133], v[220:221]
  v_pk_mul_f32 v[164:165], v[140:141], v[220:221]
  v_pk_mul_f32 v[158:159], v[134:135], v[222:223]
  s_add_u32 m0, s47, 16384
  s_add_u32 s59, s46, 16384
  v_pk_mul_f32 v[166:167], v[142:143], v[222:223]
  v_pk_fma_f32 v[152:153], v[136:137], v[224:225], v[152:153] neg_lo:[1,0,0] neg_hi:[1,0,0]
  v_pk_fma_f32 v[160:161], v[128:129], v[224:225], v[160:161]
  v_pk_fma_f32 v[154:155], v[138:139], v[226:227], v[154:155] neg_lo:[1,0,0] neg_hi:[1,0,0]
  buffer_load_dwordx4 v240, s[20:23], s59 offen offset:0 sc1 lds
  v_pk_fma_f32 v[162:163], v[130:131], v[226:227], v[162:163]
  v_pk_fma_f32 v[156:157], v[140:141], v[228:229], v[156:157] neg_lo:[1,0,0] neg_hi:[1,0,0]
  v_pk_fma_f32 v[164:165], v[132:133], v[228:229], v[164:165]
  v_pk_fma_f32 v[158:159], v[142:143], v[230:231], v[158:159] neg_lo:[1,0,0] neg_hi:[1,0,0]
  v_pk_fma_f32 v[166:167], v[134:135], v[230:231], v[166:167]
  v_cvt_pk_bf16_f32 v64, v152, -v160
  v_cvt_pk_bf16_f32 v65, v153, -v161
  v_cvt_pk_bf16_f32 v66, v154, -v162
  v_cvt_pk_bf16_f32 v67, v155, -v163
  ds_write_b128 v236, v[64:67] offset:0
  v_cvt_pk_bf16_f32 v68, v156, -v164
  v_cvt_pk_bf16_f32 v69, v157, -v165
  v_cvt_pk_bf16_f32 v70, v158, -v166
  v_cvt_pk_bf16_f32 v71, v159, -v167
  ds_write_b128 v236, v[68:71] offset:1024
  v_mfma_f32_16x16x32_bf16 v[128:131], v[64:67], v[168:171], 0
  v_mfma_f32_16x16x32_bf16 v[136:139], v[64:67], v[176:179], 0
  buffer_load_dwordx4 v240, s[20:23], s59 offen offset:1024 sc1 lds
  v_mfma_f32_16x16x32_bf16 v[132:135], v[68:71], v[168:171], 0
  v_mfma_f32_16x16x32_bf16 v[140:143], v[68:71], v[176:179], 0
  buffer_load_dwordx4 v240, s[20:23], s59 offen offset:2048 sc1 lds
  buffer_load_dwordx4 v240, s[20:23], s59 offen offset:3072 sc1 lds
  s_waitcnt vmcnt(19)
  s_waitcnt lgkmcnt(0)
  s_barrier
  ds_read_b128 v[72:75], v237 offset:0
  ds_read_b128 v[76:79], v237 offset:1024
  ds_read_b128 v[80:83], v238 offset:0
  ds_read_b128 v[84:87], v238 offset:1024
  ds_read_b128 v[88:91], v239 offset:0
  ds_read_b128 v[92:95], v239 offset:1024
  v_xor_b32 v13, v104, v254
  v_bitop3_b32 v13, v105, v255, v13 bitop3:0xbe
  v_bitop3_b32 v13, v106, v254, v13 bitop3:0xbe
  v_bitop3_b32 v13, v107, v255, v13 bitop3:0xbe
  v_bitop3_b32 v13, v108, v254, v13 bitop3:0xbe
  v_bitop3_b32 v13, v109, v255, v13 bitop3:0xbe
  v_bitop3_b32 v13, v110, v254, v13 bitop3:0xbe
  v_bitop3_b32 v13, v111, v255, v13 bitop3:0xbe
  v_and_b32 v13, 15, v13
  v_cmp_ne_u32 vcc, 0, v13
  s_nop 3
  s_cbranch_vccnz s_slow
s_ok:
  s_waitcnt lgkmcnt(5)
  s_add_u32 m0, s47, 65536
  s_add_u32 s59, s46, 65536
  v_mfma_f32_16x16x32_bf16 v[128:131], v[72:75], v[172:175], v[128:131]
  v_and_b32 v104, -16, v104
  v_and_b32 v105, -16, v105
  buffer_load_dwordx4 v240, s[20:23], s59 offen offset:0 sc1 lds
  v_mfma_f32_16x16x32_bf16 v[136:139], v[72:75], v[180:183], v[136:139]
  v_and_b32 v106, -16, v106
  v_and_b32 v107, -16, v107
  s_waitcnt lgkmcnt(4)
  v_mfma_f32_16x16x32_bf16 v[132:135], v[76:79], v[172:175], v[132:135]
  v_and_b32 v108, -16, v108
  v_and_b32 v109, -16, v109
  v_mfma_f32_16x16x32_bf16 v[140:143], v[76:79], v[180:183], v[140:143]
  v_and_b32 v110, -16, v110
  v_and_b32 v111, -16, v111
  buffer_load_dwordx4 v240, s[20:23], s59 offen offset:1024 sc1 lds
  s_waitcnt lgkmcnt(3)
  v_mfma_f32_16x16x32_bf16 v[128:131], v[80:83], v[32:35], v[128:131]
  v_mul_f32 v112, v112, v104
  v_mul_f32 v113, v113, v105
  v_mfma_f32_16x16x32_bf16 v[136:139], v[80:83], v[40:43], v[136:139]
  v_mul_f32 v114, v114, v106
  v_mul_f32 v115, v115, v107
  s_waitcnt lgkmcnt(2)
  v_mfma_f32_16x16x32_bf16 v[132:135], v[84:87], v[32:35], v[132:135]
  v_mul_f32 v116, v116, v108
  v_mul_f32 v117, v117, v109
  buffer_load_dwordx4 v240, s[20:23], s59 offen offset:2048 sc1 lds
  v_mfma_f32_16x16x32_bf16 v[140:143], v[84:87], v[40:43], v[140:143]
  v_mul_f32 v118, v118, v110
  v_mul_f32 v119, v119, v111
  s_waitcnt lgkmcnt(1)
  v_mfma_f32_16x16x32_bf16 v[128:131], v[88:91], v[36:39], v[128:131]
  v_mul_f32 v120, v120, v104
  v_mul_f32 v121, v121, v105
  v_mfma_f32_16x16x32_bf16 v[136:139], v[88:91], v[44:47], v[136:139]
  v_mul_f32 v122, v122, v106
  v_mul_f32 v123, v123, v107
  buffer_load_dwordx4 v240, s[20:23], s59 offen offset:3072 sc1 lds
  s_waitcnt lgkmcnt(0)
  v_mfma_f32_16x16x32_bf16 v[132:135], v[92:95], v[36:39], v[132:135]
  v_mul_f32 v124, v124, v108
  v_mul_f32 v125, v125, v109
  v_mfma_f32_16x16x32_bf16 v[140:143], v[92:95], v[44:47], v[140:143]
  v_mul_f32 v126, v126, v110
  v_mul_f32 v127, v127, v111
  s_add_u32 m0, s47, 32768
  s_add_u32 s59, s46, 32768
  v_pk_fma_f32 v[112:113], v[128:129], s[40:41], v[112:113] op_sel_hi:[1,0,1]
  v_pk_fma_f32 v[114:115], v[130:131], s[40:41], v[114:115] op_sel_hi:[1,0,1]
  v_pk_fma_f32 v[116:117], v[132:133], s[40:41], v[116:117] op_sel_hi:[1,0,1]
  v_pk_fma_f32 v[118:119], v[134:135], s[40:41], v[118:119] op_sel_hi:[1,0,1]
  v_cvt_pk_bf16_f32 v144, v112, v113
  v_cvt_pk_bf16_f32 v145, v114, v115
  v_cvt_pk_bf16_f32 v146, v116, v117
  v_cvt_pk_bf16_f32 v147, v118, v119
  buffer_store_dwordx4 v[144:147], v9, s[8:11], s37 offen sc1
  v_pk_fma_f32 v[120:121], v[136:137], s[44:45], v[120:121] op_sel_hi:[1,0,1]
  v_pk_fma_f32 v[122:123], v[138:139], s[44:45], v[122:123] op_sel_hi:[1,0,1]
  v_pk_fma_f32 v[124:125], v[140:141], s[44:45], v[124:125] op_sel_hi:[1,0,1]
  v_pk_fma_f32 v[126:127], v[142:143], s[44:45], v[126:127] op_sel_hi:[1,0,1]
  v_cvt_pk_bf16_f32 v148, v120, v121
  v_cvt_pk_bf16_f32 v149, v122, v123
  v_cvt_pk_bf16_f32 v150, v124, v125
  v_cvt_pk_bf16_f32 v151, v126, v127
  buffer_store_dwordx4 v[148:151], v9, s[8:11], s37 offen offset:128 sc1
  buffer_load_dwordx4 v240, s[20:23], s59 offen offset:0 sc1 lds
  buffer_load_dwordx4 v240, s[20:23], s59 offen offset:1024 sc1 lds
  buffer_load_dwordx4 v240, s[20:23], s59 offen offset:2048 sc1 lds
  buffer_load_dwordx4 v240, s[20:23], s59 offen offset:3072 sc1 lds
  v_mov_b32 v0, v240
  v_mov_b32 v5, v241
  v_mov_b32 v6, v242
  v_mov_b32 v12, v248
  s_and_b32 s36, s34, 1
  s_add_u32 m0, s47, 81920
  s_add_u32 s59, s46, 81920
  s_mul_i32 s36, s36, 49152
  buffer_load_dwordx4 v0, s[20:23], s59 offen offset:0 sc1 lds
  v_add_u32 v4, s36, v0
  v_lshlrev_b32 v8, 5, v3
  v_xor_b32 v8, v8, v0
  v_lshl_add_u32 v7, v3, 6, v2
  v_lshlrev_b32 v7, 6, v7
  s_lshr_b32 s36, s56, 3
  s_lshl4_add_u32 s36, s36, s34
  s_lshl_b32 s36, s36, 10
  s_add_u32 s36, s36, 15110144
  v_lshrrev_b32 v9, 2, v1
  v_lshlrev_b32 v9, 7, v9
  v_and_b32 v10, 3, v1
  v_lshl_add_u32 v9, v10, 3, v9
  v_add_u32 v9, 98304, v9
  buffer_load_dwordx4 v0, s[20:23], s59 offen offset:1024 sc1 lds
  v_bfe_u32 v10, v1, 3, 2
  v_xor_b32 v11, s34, v10
  v_lshl_add_u32 v11, v11, 5, v9
  s_and_b32 s37, s34, 2
  v_xor_b32 v10, s37, v10
  v_lshl_add_u32 v9, v10, 5, v9
  v_xor_b32 v10, 32, v9
  s_lshl4_add_u32 s38, s56, s34
  s_lshl_b32 s38, s38, 12
  s_add_u32 s38, s38, 4194304
  s_mov_b32 s40, 0xaaaaaaaa
  s_mov_b32 s41, 0xaaaaaaaa
  s_mov_b32 s44, 0xcccccccc
  s_mov_b32 s45, 0xcccccccc
  buffer_load_dwordx4 v0, s[20:23], s59 offen offset:2048 sc1 lds
  s_mov_b32 s32, 0x00f0000f
  s_mov_b32 s33, 0xf0000f00
  s_xor_b32 s64, s100, s60
  s_lshl_b32 s64, s64, 4
  s_lshl_b32 s62, s98, 7
  s_lshl2_add_u32 s62, s56, s62
  s_add_u32 s62, s62, s34
  s_lshl_b32 s62, s62, 10
  s_and_b32 s63, s34, 1
  s_mul_i32 s63, s63, 3
  s_lshl1_add_u32 s63, s98, s63
  s_lshl_b32 s63, s63, 5
  s_add_u32 s63, s63, s56
  s_lshr_b32 s37, s34, 1
  buffer_load_dwordx4 v0, s[20:23], s59 offen offset:3072 sc1 lds
  s_lshl1_add_u32 s63, s63, s37
  s_lshl_b32 s63, s63, 10
  s_xor_b32 s65, s64, 2048
  s_xor_b32 s66, s64, 16384
  s_xor_b32 s67, s64, 18432
  s_xor_b32 s68, s64, 32768
  s_xor_b32 s69, s64, 34816
  s_xor_b32 s70, s64, 49152
  s_waitcnt vmcnt(39)
  s_xor_b32 s71, s64, 51200
  ds_read_b128 a[4:7], v6 offset:32768
  s_add_u32 s16, s8, 11993088
  s_addc_u32 s17, s9, 0
  s_mov_b32 s18, 0
  s_mov_b32 s19, 0x20000
  ds_read_b128 a[20:23], v6 offset:33792
  s_lshl_b32 s18, s99, 14
  ds_read_b128 a[132:135], v6 offset:34816
  s_add_u32 s28, s8, 9109504
  s_addc_u32 s29, s9, 0
  s_mov_b32 s30, 2883584
  s_mov_b32 s31, 0x20000
  ds_read_b128 a[148:151], v6 offset:35840
  s_add_u32 s24, s8, 6291456
  s_addc_u32 s25, s9, 0
  s_mov_b32 s26, 0
  s_mov_b32 s27, 0x20000
  s_waitcnt vmcnt(29)
  s_lshl_b32 s26, s99, 16
  ds_read_b128 a[8:11], v6 offset:49152
  s_mov_b32 s54, 4096
  s_mov_b32 s55, 0x20000
  ds_read_b128 a[24:27], v6 offset:50176
  s_mov_b32 s50, 2097152
  s_mov_b32 s51, 0x20000
  ds_read_b128 a[136:139], v6 offset:51200
  ds_read_b128 a[152:155], v6 offset:52224
  s_waitcnt vmcnt(8)
  v_mov_b32 v14, 0
  v_mov_b32 v15, s4
  s_mov_b64 exec, 1
  buffer_store_dword v15, v14, s[8:11], s39 offen sc1
  s_mov_b64 exec, -1
  s_add_u32 s7, s7, 32768
  v_add_u32 v6, 32768, v6
  s_mov_b32 s39, s7
  s_waitcnt lgkmcnt(0)
  s_add_u32 m0, s7, 0
  s_xor_b32 s59, s100, 0
  buffer_load_dwordx4 v5, s[12:15], s59 offen offset:0 lds
  buffer_load_dwordx4 v12, s[12:15], s59 offen offset:1024 lds
  buffer_load_dwordx4 v5, s[12:15], s59 offen offset:2048 lds
  buffer_load_dwordx4 v12, s[12:15], s59 offen offset:3072 lds
  s_add_u32 m0, s7, 16384
  s_xor_b32 s59, s100, 128
  buffer_load_dwordx4 v5, s[12:15], s59 offen offset:0 lds
  buffer_load_dwordx4 v12, s[12:15], s59 offen offset:1024 lds
  buffer_load_dwordx4 v5, s[12:15], s59 offen offset:2048 lds
  buffer_load_dwordx4 v12, s[12:15], s59 offen offset:3072 lds
  s_waitcnt vmcnt(13)
  s_waitcnt vmcnt(9)
  s_barrier
  ds_read_b128 v[64:67], v4 offset:0
  s_add_u32 m0, s7, 32768
  s_xor_b32 s59, s100, 1024
  ds_read_b128 v[68:71], v4 offset:1024
  buffer_load_dwordx4 v5, s[12:15], s59 offen offset:0 lds
  ds_read_b128 v[72:75], v4 offset:2048
  ds_read_b128 v[76:79], v4 offset:3072
  ds_read_b128 v[80:83], v4 offset:4096
  ds_read_b128 v[84:87], v4 offset:5120
  buffer_load_dwordx4 v12, s[12:15], s59 offen offset:1024 lds
  ds_read_b128 v[88:91], v4 offset:6144
  ds_read_b128 v[92:95], v4 offset:7168
  ds_read_b128 v[96:99], v4 offset:8192
  ds_read_b128 v[100:103], v4 offset:9216
  buffer_load_dwordx4 v5, s[12:15], s59 offen offset:2048 lds
  ds_read_b128 v[104:107], v4 offset:10240
  ds_read_b128 v[108:111], v4 offset:11264
  ds_read_b128 v[112:115], v4 offset:12288
  ds_read_b128 v[116:119], v4 offset:13312
  buffer_load_dwordx4 v12, s[12:15], s59 offen offset:3072 lds
  ds_read_b128 v[120:123], v4 offset:14336
  s_add_u32 m0, s7, 49152
  s_xor_b32 s59, s100, 1152
  ds_read_b128 v[124:127], v4 offset:15360
  buffer_load_dwordx4 v5, s[12:15], s59 offen offset:0 lds
  ds_read_b128 v[128:131], v4 offset:16384
  s_waitcnt vmcnt(9)
  ds_read_b128 v[132:135], v4 offset:17408
  ds_read_b128 a[0:3], v6 offset:0
  ds_read_b128 v[136:139], v4 offset:18432
  buffer_load_dwordx4 v12, s[12:15], s59 offen offset:1024 lds
  ds_read_b128 v[140:143], v4 offset:19456
  ds_read_b128 a[16:19], v6 offset:1024
  ds_read_b128 v[144:147], v4 offset:20480
  ds_read_b128 v[148:151], v4 offset:21504
  buffer_load_dwordx4 v5, s[12:15], s59 offen offset:2048 lds
  ds_read_b128 v[152:155], v4 offset:22528
  ds_read_b128 a[128:131], v6 offset:2048
  ds_read_b128 v[156:159], v4 offset:23552
  ds_read_b128 v[160:163], v4 offset:24576
  buffer_load_dwordx4 v12, s[12:15], s59 offen offset:3072 lds
  ds_read_b128 v[164:167], v4 offset:25600
  ds_read_b128 a[144:147], v6 offset:3072
  ds_read_b128 v[168:171], v4 offset:26624
  s_waitcnt lgkmcnt(1)
  ds_read_b128 v[172:175], v4 offset:27648
  s_add_u32 m0, s7, 0
  s_xor_b32 s59, s100, 16512
  ds_read_b128 v[176:179], v4 offset:28672
  buffer_load_dwordx4 v5, s[12:15], s59 offen offset:0 lds
  ds_read_b128 v[180:183], v4 offset:29696
  s_waitcnt vmcnt(9)
  ds_read_b128 v[184:187], v4 offset:30720
  ds_read_b128 a[32:35], v6 offset:16384
  ds_read_b128 v[188:191], v4 offset:31744
  buffer_load_dwordx4 v12, s[12:15], s59 offen offset:1024 lds
  ds_read_b128 v[192:195], v4 offset:32768
  ds_read_b128 a[48:51], v6 offset:17408
  ds_read_b128 v[196:199], v4 offset:33792
  ds_read_b128 v[200:203], v4 offset:34816
  buffer_load_dwordx4 v5, s[12:15], s59 offen offset:2048 lds
  ds_read_b128 v[204:207], v4 offset:35840
  ds_read_b128 a[160:163], v6 offset:18432
  ds_read_b128 v[208:211], v4 offset:36864
  ds_read_b128 v[212:215], v4 offset:37888
  buffer_load_dwordx4 v12, s[12:15], s59 offen offset:3072 lds
  ds_read_b128 v[216:219], v4 offset:38912
  ds_read_b128 a[176:179], v6 offset:19456
  ds_read_b128 v[220:223], v4 offset:39936
  s_waitcnt lgkmcnt(1)
  ds_read_b128 v[224:227], v4 offset:40960
  s_add_u32 m0, s7, 16384
  s_xor_b32 s59, s100, 17408
  ds_read_b128 v[228:231], v4 offset:41984
  buffer_load_dwordx4 v5, s[12:15], s59 offen offset:0 lds
  ds_read_b128 v[232:235], v4 offset:43008
  s_waitcnt vmcnt(9)
  ds_read_b128 v[236:239], v4 offset:44032
  ds_read_b128 a[64:67], v6 offset:32768
  ds_read_b128 v[240:243], v4 offset:45056
  buffer_load_dwordx4 v12, s[12:15], s59 offen offset:1024 lds
  ds_read_b128 v[244:247], v4 offset:46080
  ds_read_b128 a[80:83], v6 offset:33792
  ds_read_b128 v[248:251], v4 offset:47104
  ds_read_b128 v[252:255], v4 offset:48128
  buffer_load_dwordx4 v5, s[12:15], s59 offen offset:2048 lds
  ds_read_b128 a[192:195], v6 offset:34816
  buffer_load_dwordx4 v12, s[12:15], s59 offen offset:3072 lds
  ds_read_b128 a[208:211], v6 offset:35840
  s_lshl_b32 s46, s98, 15
  s_lshl_b32 s47, s34, 12
  s_add_u32 s46, s46, s47
  s_mov_b64 s[20:21], s[28:29]
  s_add_u32 s22, s99, 1
  s_lshr_b32 s22, s22, 1
  s_lshl_b32 s22, s22, 17
  s_waitcnt lgkmcnt(0)
  s_add_u32 m0, s7, 32768
  s_xor_b32 s59, s100, 17536
  buffer_load_dwordx4 v5, s[12:15], s59 offen offset:0 lds
  s_waitcnt vmcnt(9)
  ds_read_b128 a[96:99], v6 offset:49152
  buffer_load_dwordx4 v12, s[12:15], s59 offen offset:1024 lds
  ds_read_b128 a[112:115], v6 offset:50176
  buffer_load_dwordx4 v5, s[12:15], s59 offen offset:2048 lds
  ds_read_b128 a[224:227], v6 offset:51200
  buffer_load_dwordx4 v12, s[12:15], s59 offen offset:3072 lds
  ds_read_b128 a[240:243], v6 offset:52224
  s_waitcnt lgkmcnt(0)
  s_add_u32 m0, s7, 49152
  s_xor_b32 s59, s100, 131200
  buffer_load_dwordx4 v5, s[12:15], s59 offen offset:0 lds
  s_waitcnt vmcnt(9)
  ds_read_b128 a[36:39], v6 offset:0
  buffer_load_dwordx4 v12, s[12:15], s59 offen offset:1024 lds
  ds_read_b128 a[52:55], v6 offset:1024
  buffer_load_dwordx4 v5, s[12:15], s59 offen offset:2048 lds
  ds_read_b128 a[164:167], v6 offset:2048
  buffer_load_dwordx4 v12, s[12:15], s59 offen offset:3072 lds
  ds_read_b128 a[180:183], v6 offset:3072
  s_waitcnt lgkmcnt(0)
  s_add_u32 m0, s7, 0
  s_xor_b32 s59, s100, 132096
  buffer_load_dwordx4 v5, s[12:15], s59 offen offset:0 lds
  s_waitcnt vmcnt(9)
  ds_read_b128 a[68:71], v6 offset:16384
  buffer_load_dwordx4 v12, s[12:15], s59 offen offset:1024 lds
  ds_read_b128 a[84:87], v6 offset:17408
  buffer_load_dwordx4 v5, s[12:15], s59 offen offset:2048 lds
  ds_read_b128 a[196:199], v6 offset:18432
  buffer_load_dwordx4 v12, s[12:15], s59 offen offset:3072 lds
  ds_read_b128 a[212:215], v6 offset:19456
  buffer_load_dword v15, v7, s[8:11], s36 offen sc1
  s_waitcnt vmcnt(9)
  ds_read_b128 a[100:103], v6 offset:32768
  ds_read_b128 a[116:119], v6 offset:33792
  ds_read_b128 a[228:231], v6 offset:34816
  ds_read_b128 a[244:247], v6 offset:35840
  s_waitcnt vmcnt(5)
  ds_read_b128 a[40:43], v6 offset:49152
  ds_read_b128 a[56:59], v6 offset:50176
  ds_read_b128 a[168:171], v6 offset:51200
  ds_read_b128 a[184:187], v6 offset:52224
  s_waitcnt vmcnt(1)
  ds_read_b128 a[72:75], v6 offset:0
  ds_read_b128 a[88:91], v6 offset:1024
  ds_read_b128 a[200:203], v6 offset:2048
  ds_read_b128 a[216:219], v6 offset:3072
  s_waitcnt lgkmcnt(0)
  s_barrier
  s_waitcnt vmcnt(0)
  v_cmp_ne_u32 vcc, s4, v15
  s_nop 3
  s_cbranch_vccnz h_slow
h_ok:
  s_add_u32 m0, s39, 0
  s_add_u32 s59, s38, 0
  buffer_load_dwordx4 v8, s[8:11], s59 offen offset:0 sc1 lds
  buffer_load_dwordx4 v8, s[8:11], s59 offen offset:1024 sc1 lds
  buffer_load_dwordx4 v8, s[8:11], s59 offen offset:2048 sc1 lds
  buffer_load_dwordx4 v8, s[8:11], s59 offen offset:3072 sc1 lds
  s_add_u32 m0, s39, 16384
  s_add_u32 s59, s38, 16384
  buffer_load_dwordx4 v8, s[8:11], s59 offen offset:0 sc1 lds
  buffer_load_dwordx4 v8, s[8:11], s59 offen offset:1024 sc1 lds
  buffer_load_dwordx4 v8, s[8:11], s59 offen offset:2048 sc1 lds
  buffer_load_dwordx4 v8, s[8:11], s59 offen offset:3072 sc1 lds
  s_add_u32 m0, s39, 32768
  s_add_u32 s59, s38, 32768
  buffer_load_dwordx4 v8, s[8:11], s59 offen offset:0 sc1 lds
  buffer_load_dwordx4 v8, s[8:11], s59 offen offset:1024 sc1 lds
  buffer_load_dwordx4 v8, s[8:11], s59 offen offset:2048 sc1 lds
  buffer_load_dwordx4 v8, s[8:11], s59 offen offset:3072 sc1 lds
  s_waitcnt vmcnt(8)
  s_barrier
  ds_read_b64_tr_b16 v[40:41], v9 offset:0
  ds_read_b64_tr_b16 v[42:43], v9 offset:2048
  ds_read_b64_tr_b16 v[44:45], v10 offset:0
  ds_read_b64_tr_b16 v[46:47], v10 offset:2048
  ds_read_b64_tr_b16 v[48:49], v9 offset:4096
  ds_read_b64_tr_b16 v[50:51], v9 offset:6144
  ds_read_b64_tr_b16 v[52:53], v10 offset:4096
  ds_read_b64_tr_b16 v[54:55], v10 offset:6144
  s_waitcnt lgkmcnt(4)
  v_mfma_f32_16x16x32_bf16 v[4:7], v[40:43], v[40:43], 0
  ds_read_b64_tr_b16 v[56:57], v9 offset:8192
  s_add_u32 m0, s39, 49152
  s_add_u32 s59, s38, 49152
  v_mfma_f32_16x16x32_bf16 v[12:15], v[44:47], v[44:47], 0
  ds_read_b64_tr_b16 v[58:59], v9 offset:10240
  buffer_load_dwordx4 v8, s[8:11], s59 offen offset:0 sc1 lds
  v_mfma_f32_16x16x32_bf16 v[16:19], v[40:43], v[64:67], 0
  ds_read_b64_tr_b16 v[60:61], v10 offset:8192
  v_mfma_f32_16x16x32_bf16 v[28:31], v[44:47], v[64:67], 0
  ds_read_b64_tr_b16 v[62:63], v10 offset:10240
  v_mfma_f32_16x16x32_bf16 v[20:23], v[40:43], v[128:131], 0
  v_mfma_f32_16x16x32_bf16 v[32:35], v[44:47], v[128:131], 0
  buffer_load_dwordx4 v8, s[8:11], s59 offen offset:1024 sc1 lds
  v_mfma_f32_16x16x32_bf16 v[24:27], v[40:43], v[192:195], 0
  v_mfma_f32_16x16x32_bf16 v[36:39], v[44:47], v[192:195], 0
  s_waitcnt lgkmcnt(4)
  v_mfma_f32_16x16x32_bf16 v[4:7], v[48:51], v[48:51], v[4:7]
  ds_read_b64_tr_b16 v[40:41], v9 offset:12288
  v_mfma_f32_16x16x32_bf16 v[12:15], v[52:55], v[52:55], v[12:15]
  ds_read_b64_tr_b16 v[42:43], v9 offset:14336
  buffer_load_dwordx4 v8, s[8:11], s59 offen offset:2048 sc1 lds
  v_mfma_f32_16x16x32_bf16 v[16:19], v[48:51], v[68:71], v[16:19]
  ds_read_b64_tr_b16 v[44:45], v10 offset:12288
  v_mfma_f32_16x16x32_bf16 v[28:31], v[52:55], v[68:71], v[28:31]
  ds_read_b64_tr_b16 v[46:47], v10 offset:14336
  v_mfma_f32_16x16x32_bf16 v[20:23], v[48:51], v[132:135], v[20:23]
  ds_read_b64_tr_b16 v[64:65], v11 offset:0
  v_mfma_f32_16x16x32_bf16 v[32:35], v[52:55], v[132:135], v[32:35]
  ds_read_b64_tr_b16 v[66:67], v11 offset:2048
  buffer_load_dwordx4 v8, s[8:11], s59 offen offset:3072 sc1 lds
  v_mfma_f32_16x16x32_bf16 v[24:27], v[48:51], v[196:199], v[24:27]
  v_mfma_f32_16x16x32_bf16 v[36:39], v[52:55], v[196:199], v[36:39]
  s_waitcnt lgkmcnt(6)
  v_mfma_f32_16x16x32_bf16 v[4:7], v[56:59], v[56:59], v[4:7]
  s_waitcnt vmcnt(8)
  s_barrier
  s_add_u32 m0, s47, 0
  s_add_u32 s59, s46, 0
  v_mfma_f32_16x16x32_bf16 v[12:15], v[60:63], v[60:63], v[12:15]
  ds_read_b64_tr_b16 v[48:49], v9 offset:16384
  buffer_load_dwordx4 v0, s[16:19], s59 offen offset:0 sc1 lds
  v_mfma_f32_16x16x32_bf16 v[16:19], v[56:59], v[72:75], v[16:19]
  ds_read_b64_tr_b16 v[50:51], v9 offset:18432
  v_mfma_f32_16x16x32_bf16 v[28:31], v[60:63], v[72:75], v[28:31]
  ds_read_b64_tr_b16 v[52:53], v10 offset:16384
  v_mfma_f32_16x16x32_bf16 v[20:23], v[56:59], v[136:139], v[20:23]
  ds_read_b64_tr_b16 v[54:55], v10 offset:18432
  v_mfma_f32_16x16x32_bf16 v[32:35], v[60:63], v[136:139], v[32:35]
  ds_read_b64_tr_b16 v[68:69], v11 offset:4096
  buffer_load_dwordx4 v0, s[16:19], s59 offen offset:1024 sc1 lds
  v_mfma_f32_16x16x32_bf16 v[24:27], v[56:59], v[200:203], v[24:27]
  ds_read_b64_tr_b16 v[70:71], v11 offset:6144
  v_mfma_f32_16x16x32_bf16 v[36:39], v[60:63], v[200:203], v[36:39]
  s_waitcnt lgkmcnt(8)
  v_mfma_f32_16x16x32_bf16 v[4:7], v[40:43], v[40:43], v[4:7]
  ds_read_b64_tr_b16 v[56:57], v9 offset:20480
  v_mfma_f32_16x16x32_bf16 v[12:15], v[44:47], v[44:47], v[12:15]
  ds_read_b64_tr_b16 v[58:59], v9 offset:22528
  buffer_load_dwordx4 v0, s[16:19], s59 offen offset:2048 sc1 lds
  v_mfma_f32_16x16x32_bf16 v[16:19], v[40:43], v[76:79], v[16:19]
  ds_read_b64_tr_b16 v[60:61], v10 offset:20480
  v_mfma_f32_16x16x32_bf16 v[28:31], v[44:47], v[76:79], v[28:31]
  ds_read_b64_tr_b16 v[62:63], v10 offset:22528
  v_mfma_f32_16x16x32_bf16 v[20:23], v[40:43], v[140:143], v[20:23]
  ds_read_b64_tr_b16 v[72:73], v11 offset:8192
  v_mfma_f32_16x16x32_bf16 v[32:35], v[44:47], v[140:143], v[32:35]
  ds_read_b64_tr_b16 v[74:75], v11 offset:10240
  buffer_load_dwordx4 v0, s[16:19], s59 offen offset:3072 sc1 lds
  v_mfma_f32_16x16x32_bf16 v[24:27], v[40:43], v[204:207], v[24:27]
  v_mfma_f32_16x16x32_bf16 v[36:39], v[44:47], v[204:207], v[36:39]
  s_waitcnt lgkmcnt(8)
  v_mfma_f32_16x16x32_bf16 v[4:7], v[48:51], v[48:51], v[4:7]
  ds_read_b64_tr_b16 v[40:41], v9 offset:24576
  s_add_u32 m0, s47, 16384
  s_add_u32 s59, s46, 16384
  v_mfma_f32_16x16x32_bf16 v[12:15], v[52:55], v[52:55], v[12:15]
  ds_read_b64_tr_b16 v[42:43], v9 offset:26624
  buffer_load_dwordx4 v0, s[16:19], s59 offen offset:0 sc1 lds
  v_mfma_f32_16x16x32_bf16 v[16:19], v[48:51], v[80:83], v[16:19]
  ds_read_b64_tr_b16 v[44:45], v10 offset:24576
  v_mfma_f32_16x16x32_bf16 v[28:31], v[52:55], v[80:83], v[28:31]
  ds_read_b64_tr_b16 v[46:47], v10 offset:26624
  v_mfma_f32_16x16x32_bf16 v[20:23], v[48:51], v[144:147], v[20:23]
  ds_read_b64_tr_b16 v[76:77], v11 offset:12288
  v_mfma_f32_16x16x32_bf16 v[32:35], v[52:55], v[144:147], v[32:35]
  ds_read_b64_tr_b16 v[78:79], v11 offset:14336
  buffer_load_dwordx4 v0, s[16:19], s59 offen offset:1024 sc1 lds
  v_mfma_f32_16x16x32_bf16 v[24:27], v[48:51], v[208:211], v[24:27]
  v_mfma_f32_16x16x32_bf16 v[36:39], v[52:55], v[208:211], v[36:39]
  s_waitcnt lgkmcnt(8)
  v_mfma_f32_16x16x32_bf16 v[4:7], v[56:59], v[56:59], v[4:7]
  ds_read_b64_tr_b16 v[48:49], v9 offset:28672
  v_mfma_f32_16x16x32_bf16 v[12:15], v[60:63], v[60:63], v[12:15]
  ds_read_b64_tr_b16 v[50:51], v9 offset:30720
  buffer_load_dwordx4 v0, s[16:19], s59 offen offset:2048 sc1 lds
  v_mfma_f32_16x16x32_bf16 v[16:19], v[56:59], v[84:87], v[16:19]
  ds_read_b64_tr_b16 v[52:53], v10 offset:28672
  v_mfma_f32_16x16x32_bf16 v[28:31], v[60:63], v[84:87], v[28:31]
  ds_read_b64_tr_b16 v[54:55], v10 offset:30720
  v_mfma_f32_16x16x32_bf16 v[20:23], v[56:59], v[148:151], v[20:23]
  ds_read_b64_tr_b16 v[80:81], v11 offset:16384
  v_mfma_f32_16x16x32_bf16 v[32:35], v[60:63], v[148:151], v[32:35]
  ds_read_b64_tr_b16 v[82:83], v11 offset:18432
  buffer_load_dwordx4 v0, s[16:19], s59 offen offset:3072 sc1 lds
  v_mfma_f32_16x16x32_bf16 v[24:27], v[56:59], v[212:215], v[24:27]
  v_mfma_f32_16x16x32_bf16 v[36:39], v[60:63], v[212:215], v[36:39]
  s_waitcnt lgkmcnt(8)
  v_mfma_f32_16x16x32_bf16 v[4:7], v[40:43], v[40:43], v[4:7]
  s_waitcnt vmcnt(12)
  s_barrier
  s_add_u32 m0, s47, 32768
  s_add_u32 s59, s46, 32768
  v_mfma_f32_16x16x32_bf16 v[12:15], v[44:47], v[44:47], v[12:15]
  ds_read_b64_tr_b16 v[56:57], v9 offset:32768
  buffer_load_dwordx4 v0, s[16:19], s59 offen offset:0 sc1 lds
  v_mfma_f32_16x16x32_bf16 v[16:19], v[40:43], v[88:91], v[16:19]
  ds_read_b64_tr_b16 v[58:59], v9 offset:34816
  v_mfma_f32_16x16x32_bf16 v[28:31], v[44:47], v[88:91], v[28:31]
  ds_read_b64_tr_b16 v[60:61], v10 offset:32768
  v_mfma_f32_16x16x32_bf16 v[20:23], v[40:43], v[152:155], v[20:23]
  ds_read_b64_tr_b16 v[62:63], v10 offset:34816
  v_mfma_f32_16x16x32_bf16 v[32:35], v[44:47], v[152:155], v[32:35]
  ds_read_b64_tr_b16 v[84:85], v11 offset:20480
  buffer_load_dwordx4 v0, s[16:19], s59 offen offset:1024 sc1 lds
  v_mfma_f32_16x16x32_bf16 v[24:27], v[40:43], v[216:219], v[24:27]
  ds_read_b64_tr_b16 v[86:87], v11 offset:22528
  v_mfma_f32_16x16x32_bf16 v[36:39], v[44:47], v[216:219], v[36:39]
  s_waitcnt lgkmcnt(8)
  v_mfma_f32_16x16x32_bf16 v[4:7], v[48:51], v[48:51], v[4:7]
  ds_read_b64_tr_b16 v[40:41], v9 offset:36864
  v_mfma_f32_16x16x32_bf16 v[12:15], v[52:55], v[52:55], v[12:15]
  ds_read_b64_tr_b16 v[42:43], v9 offset:38912
  buffer_load_dwordx4 v0, s[16:19], s59 offen offset:2048 sc1 lds
  v_mfma_f32_16x16x32_bf16 v[16:19], v[48:51], v[92:95], v[16:19]
  ds_read_b64_tr_b16 v[44:45], v10 offset:36864
  v_mfma_f32_16x16x32_bf16 v[28:31], v[52:55], v[92:95], v[28:31]
  ds_read_b64_tr_b16 v[46:47], v10 offset:38912
  v_mfma_f32_16x16x32_bf16 v[20:23], v[48:51], v[156:159], v[20:23]
  ds_read_b64_tr_b16 v[88:89], v11 offset:24576
  v_mfma_f32_16x16x32_bf16 v[32:35], v[52:55], v[156:159], v[32:35]
  ds_read_b64_tr_b16 v[90:91], v11 offset:26624
  buffer_load_dwordx4 v0, s[16:19], s59 offen offset:3072 sc1 lds
  v_mfma_f32_16x16x32_bf16 v[24:27], v[48:51], v[220:223], v[24:27]
  v_mfma_f32_16x16x32_bf16 v[36:39], v[52:55], v[220:223], v[36:39]
  s_waitcnt lgkmcnt(8)
  v_mfma_f32_16x16x32_bf16 v[4:7], v[56:59], v[56:59], v[4:7]
  ds_read_b64_tr_b16 v[48:49], v9 offset:40960
  s_add_u32 m0, s47, 49152
  s_add_u32 s59, s46, 49152
  v_mfma_f32_16x16x32_bf16 v[12:15], v[60:63], v[60:63], v[12:15]
  ds_read_b64_tr_b16 v[50:51], v9 offset:43008
  buffer_load_dwordx4 v0, s[16:19], s59 offen offset:0 sc1 lds
  v_mfma_f32_16x16x32_bf16 v[16:19], v[56:59], v[96:99], v[16:19]
  ds_read_b64_tr_b16 v[52:53], v10 offset:40960
  v_mfma_f32_16x16x32_bf16 v[28:31], v[60:63], v[96:99], v[28:31]
  ds_read_b64_tr_b16 v[54:55], v10 offset:43008
  v_mfma_f32_16x16x32_bf16 v[20:23], v[56:59], v[160:163], v[20:23]
  ds_read_b64_tr_b16 v[92:93], v11 offset:28672
  v_mfma_f32_16x16x32_bf16 v[32:35], v[60:63], v[160:163], v[32:35]
  ds_read_b64_tr_b16 v[94:95], v11 offset:30720
  buffer_load_dwordx4 v0, s[16:19], s59 offen offset:1024 sc1 lds
  v_mfma_f32_16x16x32_bf16 v[24:27], v[56:59], v[224:227], v[24:27]
  v_mfma_f32_16x16x32_bf16 v[36:39], v[60:63], v[224:227], v[36:39]
  s_waitcnt lgkmcnt(8)
  v_mfma_f32_16x16x32_bf16 v[4:7], v[40:43], v[40:43], v[4:7]
  ds_read_b64_tr_b16 v[56:57], v9 offset:45056
  v_mfma_f32_16x16x32_bf16 v[12:15], v[44:47], v[44:47], v[12:15]
  ds_read_b64_tr_b16 v[58:59], v9 offset:47104
  buffer_load_dwordx4 v0, s[16:19], s59 offen offset:2048 sc1 lds
  v_mfma_f32_16x16x32_bf16 v[16:19], v[40:43], v[100:103], v[16:19]
  ds_read_b64_tr_b16 v[60:61], v10 offset:45056
  v_mfma_f32_16x16x32_bf16 v[28:31], v[44:47], v[100:103], v[28:31]
  ds_read_b64_tr_b16 v[62:63], v10 offset:47104
  v_mfma_f32_16x16x32_bf16 v[20:23], v[40:43], v[164:167], v[20:23]
  ds_read_b64_tr_b16 v[96:97], v11 offset:32768
  v_mfma_f32_16x16x32_bf16 v[32:35], v[44:47], v[164:167], v[32:35]
  ds_read_b64_tr_b16 v[98:99], v11 offset:34816
  buffer_load_dwordx4 v0, s[16:19], s59 offen offset:3072 sc1 lds
  v_mfma_f32_16x16x32_bf16 v[24:27], v[40:43], v[228:231], v[24:27]
  v_mfma_f32_16x16x32_bf16 v[36:39], v[44:47], v[228:231], v[36:39]
  s_waitcnt lgkmcnt(8)
  v_mfma_f32_16x16x32_bf16 v[4:7], v[48:51], v[48:51], v[4:7]
  s_waitcnt vmcnt(16)
  s_barrier
  s_add_u32 m0, s47, 65536
  s_add_u32 s59, s46, 65536
  v_mfma_f32_16x16x32_bf16 v[12:15], v[52:55], v[52:55], v[12:15]
  ds_read_b64_tr_b16 v[40:41], v9 offset:49152
  buffer_load_dwordx4 v0, s[16:19], s59 offen offset:0 sc1 lds
  v_mfma_f32_16x16x32_bf16 v[16:19], v[48:51], v[104:107], v[16:19]
  ds_read_b64_tr_b16 v[42:43], v9 offset:51200
  v_mfma_f32_16x16x32_bf16 v[28:31], v[52:55], v[104:107], v[28:31]
  ds_read_b64_tr_b16 v[44:45], v10 offset:49152
  v_mfma_f32_16x16x32_bf16 v[20:23], v[48:51], v[168:171], v[20:23]
  ds_read_b64_tr_b16 v[46:47], v10 offset:51200
  v_mfma_f32_16x16x32_bf16 v[32:35], v[52:55], v[168:171], v[32:35]
  ds_read_b64_tr_b16 v[100:101], v11 offset:36864
  buffer_load_dwordx4 v0, s[16:19], s59 offen offset:1024 sc1 lds
  v_mfma_f32_16x16x32_bf16 v[24:27], v[48:51], v[232:235], v[24:27]
  ds_read_b64_tr_b16 v[102:103], v11 offset:38912
  v_mfma_f32_16x16x32_bf16 v[36:39], v[52:55], v[232:235], v[36:39]
  s_waitcnt lgkmcnt(8)
  v_mfma_f32_16x16x32_bf16 v[4:7], v[56:59], v[56:59], v[4:7]
  ds_read_b64_tr_b16 v[48:49], v9 offset:53248
  v_mfma_f32_16x16x32_bf16 v[12:15], v[60:63], v[60:63], v[12:15]
  ds_read_b64_tr_b16 v[50:51], v9 offset:55296
  buffer_load_dwordx4 v0, s[16:19], s59 offen offset:2048 sc1 lds
  v_mfma_f32_16x16x32_bf16 v[16:19], v[56:59], v[108:111], v[16:19]
  ds_read_b64_tr_b16 v[52:53], v10 offset:53248
  v_mfma_f32_16x16x32_bf16 v[28:31], v[60:63], v[108:111], v[28:31]
  ds_read_b64_tr_b16 v[54:55], v10 offset:55296
  v_mfma_f32_16x16x32_bf16 v[20:23], v[56:59], v[172:175], v[20:23]
  ds_read_b64_tr_b16 v[104:105], v11 offset:40960
  v_mfma_f32_16x16x32_bf16 v[32:35], v[60:63], v[172:175], v[32:35]
  ds_read_b64_tr_b16 v[106:107], v11 offset:43008
  buffer_load_dwordx4 v0, s[16:19], s59 offen offset:3072 sc1 lds
  v_mfma_f32_16x16x32_bf16 v[24:27], v[56:59], v[236:239], v[24:27]
  v_mfma_f32_16x16x32_bf16 v[36:39], v[60:63], v[236:239], v[36:39]
  s_waitcnt lgkmcnt(8)
  v_mfma_f32_16x16x32_bf16 v[4:7], v[40:43], v[40:43], v[4:7]
  ds_read_b64_tr_b16 v[56:57], v9 offset:57344
  s_add_u32 m0, s47, 81920
  s_add_u32 s59, s46, 81920
  v_mfma_f32_16x16x32_bf16 v[12:15], v[44:47], v[44:47], v[12:15]
  ds_read_b64_tr_b16 v[58:59], v9 offset:59392
  buffer_load_dwordx4 v0, s[16:19], s59 offen offset:0 sc1 lds
  v_mfma_f32_16x16x32_bf16 v[16:19], v[40:43], v[112:115], v[16:19]
  ds_read_b64_tr_b16 v[60:61], v10 offset:57344
  v_mfma_f32_16x16x32_bf16 v[28:31], v[44:47], v[112:115], v[28:31]
  ds_read_b64_tr_b16 v[62:63], v10 offset:59392
  v_mfma_f32_16x16x32_bf16 v[20:23], v[40:43], v[176:179], v[20:23]
  ds_read_b64_tr_b16 v[108:109], v11 offset:45056
  v_mfma_f32_16x16x32_bf16 v[32:35], v[44:47], v[176:179], v[32:35]
  ds_read_b64_tr_b16 v[110:111], v11 offset:47104
  buffer_load_dwordx4 v0, s[16:19], s59 offen offset:1024 sc1 lds
  v_mfma_f32_16x16x32_bf16 v[24:27], v[40:43], v[240:243], v[24:27]
  v_mfma_f32_16x16x32_bf16 v[36:39], v[44:47], v[240:243], v[36:39]
  s_waitcnt lgkmcnt(8)
  v_mfma_f32_16x16x32_bf16 v[4:7], v[48:51], v[48:51], v[4:7]
  ds_read_b64_tr_b16 v[40:41], v9 offset:61440
  v_mfma_f32_16x16x32_bf16 v[12:15], v[52:55], v[52:55], v[12:15]
  ds_read_b64_tr_b16 v[42:43], v9 offset:63488
  buffer_load_dwordx4 v0, s[16:19], s59 offen offset:2048 sc1 lds
  v_mfma_f32_16x16x32_bf16 v[16:19], v[48:51], v[116:119], v[16:19]
  ds_read_b64_tr_b16 v[44:45], v10 offset:61440
  v_mfma_f32_16x16x32_bf16 v[28:31], v[52:55], v[116:119], v[28:31]
  ds_read_b64_tr_b16 v[46:47], v10 offset:63488
  v_mfma_f32_16x16x32_bf16 v[20:23], v[48:51], v[180:183], v[20:23]
  ds_read_b64_tr_b16 v[112:113], v11 offset:49152
  v_mfma_f32_16x16x32_bf16 v[32:35], v[52:55], v[180:183], v[32:35]
  ds_read_b64_tr_b16 v[114:115], v11 offset:51200
  buffer_load_dwordx4 v0, s[16:19], s59 offen offset:3072 sc1 lds
  v_mfma_f32_16x16x32_bf16 v[24:27], v[48:51], v[244:247], v[24:27]
  v_mfma_f32_16x16x32_bf16 v[36:39], v[52:55], v[244:247], v[36:39]
  s_waitcnt lgkmcnt(8)
  v_mfma_f32_16x16x32_bf16 v[4:7], v[56:59], v[56:59], v[4:7]
  ds_read_b64_tr_b16 v[116:117], v11 offset:53248
  v_mfma_f32_16x16x32_bf16 v[12:15], v[60:63], v[60:63], v[12:15]
  ds_read_b64_tr_b16 v[118:119], v11 offset:55296
  v_mfma_f32_16x16x32_bf16 v[16:19], v[56:59], v[120:123], v[16:19]
  v_mfma_f32_16x16x32_bf16 v[28:31], v[60:63], v[120:123], v[28:31]
  v_mfma_f32_16x16x32_bf16 v[20:23], v[56:59], v[184:187], v[20:23]
  v_mfma_f32_16x16x32_bf16 v[32:35], v[60:63], v[184:187], v[32:35]
  v_mfma_f32_16x16x32_bf16 v[24:27], v[56:59], v[248:251], v[24:27]
  v_mfma_f32_16x16x32_bf16 v[36:39], v[60:63], v[248:251], v[36:39]
  s_waitcnt lgkmcnt(4)
  v_mfma_f32_16x16x32_bf16 v[4:7], v[40:43], v[40:43], v[4:7]
  ds_read_b64_tr_b16 v[120:121], v11 offset:57344
  v_mfma_f32_16x16x32_bf16 v[12:15], v[44:47], v[44:47], v[12:15]
  ds_read_b64_tr_b16 v[122:123], v11 offset:59392
  v_mfma_f32_16x16x32_bf16 v[16:19], v[40:43], v[124:127], v[16:19]
  v_mfma_f32_16x16x32_bf16 v[28:31], v[44:47], v[124:127], v[28:31]
  v_mfma_f32_16x16x32_bf16 v[20:23], v[40:43], v[188:191], v[20:23]
  v_mfma_f32_16x16x32_bf16 v[32:35], v[44:47], v[188:191], v[32:35]
  v_mfma_f32_16x16x32_bf16 v[24:27], v[40:43], v[252:255], v[24:27]
  v_mfma_f32_16x16x32_bf16 v[36:39], v[44:47], v[252:255], v[36:39]
  ds_read_b64_tr_b16 v[124:125], v11 offset:61440
  ds_read_b64_tr_b16 v[126:127], v11 offset:63488
  v_lshrrev_b32 v1, 4, v0
  v_mov_b32 v172, -1
  v_mov_b32 v173, -1
  v_mov_b32 v174, -1
  v_mov_b32 v175, -1
  v_mov_b32 v59, 0x3727c5ac
  v_mov_b32_e64 v58, 1.0
  buffer_store_dwordx4 v[172:175], v0, s[20:23], s62 offen sc1
  s_add_u32 s62, s62, 131072
  v_cndmask_b32 v4, v4, v5, s[40:41]
  v_cndmask_b32 v6, v6, v7, s[40:41]
  v_cndmask_b32 v12, v12, v13, s[40:41]
  v_cndmask_b32 v14, v14, v15, s[40:41]
  v_cndmask_b32 v4, v4, v6, s[44:45]
  v_cndmask_b32 v12, v12, v14, s[44:45]
  v_fmamk_f32 v4, v4, 0x3b000000, v59
  v_fmamk_f32 v12, v12, 0x3b000000, v59
  v_rsq_f32 v4, v4
  v_rsq_f32 v12, v12
  v_cndmask_b32 v56, 0, v4, s[32:33]
  v_cndmask_b32 v57, 0, v12, s[32:33]
  s_nop 0
  v_mfma_f32_16x16x4_f32 v[128:131], v56, v58, 0
  buffer_store_dwordx4 v[172:175], v0, s[20:23], s62 offen sc1
  s_add_u32 s62, s62, 131072
  v_mfma_f32_16x16x4_f32 v[132:135], v57, v58, 0
  v_mov_b32 v60, 0xc0135761
  v_mov_b32 v61, 0xc0135761
  v_mov_b32 v62, 0xbdd2d3e8
  v_mov_b32 v63, 0xbdd2d3e8
  s_lshr_b32 s38, s34, 1
  s_lshl1_add_u32 s38, s56, s38
  s_lshl_b32 s39, s38, 12
  s_add_u32 s39, s39, 14647296
  s_and_b32 s40, s34, 1
  s_lshl1_add_u32 s36, s57, s40
  s_lshl_b32 s36, s36, 8
  s_add_u32 s36, s36, s39
  buffer_store_dwordx4 v[172:175], v0, s[20:23], s62 offen sc1
  s_add_u32 s62, s62, 131072
  s_cmp_eq_u32 s40, 1
  s_cselect_b64 vcc, -1, 0
  v_cndmask_b32 v56, v56, v57, vcc
  s_lshr_b32 s42, s60, 12
  v_and_b32 v10, 12, v2
  v_add3_u32 v10, v10, v2, s42
  v_lshlrev_b32 v13, 1, v10
  buffer_load_ushort v52, v13, s[52:55], 0 offen
  v_lshrrev_b32 v13, 7, v10
  v_bfe_u32 v14, v10, 1, 4
  v_lshl_add_u32 v13, v13, 4, v14
  v_bfe_u32 v14, v10, 5, 2
  v_lshlrev_b32 v14, 3, v14
  v_lshl_add_u32 v13, v13, 7, v14
  v_and_b32 v14, 1, v10
  v_lshl_add_u32 v13, v14, 2, v13
  s_mov_b32 s42, 14909472
  buffer_load_dword v53, v13, s[8:11], s42 offen sc1
  v_bfe_u32 v7, v1, 2, 2
  v_lshl_add_u32 v6, v3, 3, v7
  v_lshlrev_b32 v4, 12, v6
  v_sub_u32 v6, 0, v3
  v_xor_b32 v6, v6, v1
  v_and_b32 v6, 3, v6
  v_lshl_add_u32 v6, v6, 4, v4
  v_add_u32 v4, 1024, v6
  v_add_u32 v55, 64, v6
  v_bfe_u32 v7, v1, 2, 2
  v_sub_u32 v6, 0, v7
  v_xor_b32 v6, v6, v3
  v_and_b32 v6, 3, v6
  v_lshl_add_u32 v6, v2, 2, v6
  v_lshl_add_u32 v5, v6, 4, s7
  v_and_b32 v12, 60, v1
  v_lshlrev_b32 v12, 2, v12
  s_mov_b32 s44, 0x11111111
  s_mov_b32 s45, 0x11111111
  s_lshl_b32 s37, s57, 6
  s_add_u32 s37, s37, s38
  s_lshl1_add_u32 s37, s37, s40
  s_lshl_b32 s37, s37, 6
  s_add_u32 s37, s37, 15175680
  s_waitcnt lgkmcnt(0)
  s_barrier
  v_pk_mul_f32 v[16:17], v[16:17], v[128:129]
  s_add_u32 m0, s7, 0
  s_xor_b32 s59, s100, 147456
  v_pk_mul_f32 v[18:19], v[18:19], v[130:131]
  buffer_load_dwordx4 v4, s[12:15], s59 offen offset:0 lds
  v_pk_mul_f32 v[20:21], v[20:21], v[128:129]
  v_pk_mul_f32 v[22:23], v[22:23], v[130:131]
  v_pk_mul_f32 v[24:25], v[24:25], v[128:129]
  v_pk_mul_f32 v[26:27], v[26:27], v[130:131]
  v_pk_mul_f32 v[28:29], v[28:29], v[132:133]
  v_pk_mul_f32 v[30:31], v[30:31], v[134:135]
  v_pk_mul_f32 v[32:33], v[32:33], v[132:133]
  v_pk_mul_f32 v[34:35], v[34:35], v[134:135]
  v_pk_mul_f32 v[36:37], v[36:37], v[132:133]
  v_pk_mul_f32 v[38:39], v[38:39], v[134:135]
  v_pk_mul_f32 v[136:137], v[16:17], v[16:17]
  v_pk_mul_f32 v[138:139], v[18:19], v[18:19]
  v_pk_mul_f32 v[140:141], v[20:21], v[20:21]
  v_pk_mul_f32 v[142:143], v[22:23], v[22:23]
  v_pk_fma_f32 v[136:137], v[136:137], v[62:63], v[60:61]
  v_pk_fma_f32 v[138:139], v[138:139], v[62:63], v[60:61]
  v_pk_fma_f32 v[140:141], v[140:141], v[62:63], v[60:61]
  buffer_load_dwordx4 v55, s[12:15], s59 offen offset:1024 lds
  v_pk_fma_f32 v[142:143], v[142:143], v[62:63], v[60:61]
  v_pk_mul_f32 v[136:137], v[136:137], v[16:17]
  v_pk_mul_f32 v[138:139], v[138:139], v[18:19]
  v_pk_mul_f32 v[140:141], v[140:141], v[20:21]
  v_pk_mul_f32 v[142:143], v[142:143], v[22:23]
  v_exp_f32 v136, v136
  v_exp_f32 v137, v137
  v_exp_f32 v138, v138
  v_exp_f32 v139, v139
  v_exp_f32 v140, v140
  v_exp_f32 v141, v141
  buffer_load_dwordx4 v4, s[12:15], s59 offen offset:2048 lds
  v_exp_f32 v142, v142
  v_exp_f32 v143, v143
  v_pk_add_f32 v[136:137], v[136:137], 1.0 op_sel_hi:[1,0]
  v_pk_add_f32 v[138:139], v[138:139], 1.0 op_sel_hi:[1,0]
  v_pk_add_f32 v[140:141], v[140:141], 1.0 op_sel_hi:[1,0]
  v_pk_add_f32 v[142:143], v[142:143], 1.0 op_sel_hi:[1,0]
  v_rcp_f32 v136, v136
  v_rcp_f32 v137, v137
  v_rcp_f32 v138, v138
  v_rcp_f32 v139, v139
  v_rcp_f32 v140, v140
  buffer_load_dwordx4 v55, s[12:15], s59 offen offset:3072 lds
  v_rcp_f32 v141, v141
  v_rcp_f32 v142, v142
  v_rcp_f32 v143, v143
  v_pk_mul_f32 v[16:17], v[16:17], v[136:137]
  v_pk_mul_f32 v[18:19], v[18:19], v[138:139]
  v_pk_mul_f32 v[20:21], v[20:21], v[140:141]
  v_pk_mul_f32 v[22:23], v[22:23], v[142:143]
  v_pk_mul_f32 v[136:137], v[24:25], v[24:25]
  s_add_u32 m0, s7, 16384
  s_xor_b32 s59, s100, 132224
  v_pk_mul_f32 v[138:139], v[26:27], v[26:27]
  v_pk_mul_f32 v[140:141], v[28:29], v[28:29]
  v_pk_mul_f32 v[142:143], v[30:31], v[30:31]
  v_pk_fma_f32 v[136:137], v[136:137], v[62:63], v[60:61]
  buffer_load_dwordx4 v4, s[12:15], s59 offen offset:0 lds
  v_pk_fma_f32 v[138:139], v[138:139], v[62:63], v[60:61]
  v_pk_fma_f32 v[140:141], v[140:141], v[62:63], v[60:61]
  v_pk_fma_f32 v[142:143], v[142:143], v[62:63], v[60:61]
  v_pk_mul_f32 v[136:137], v[136:137], v[24:25]
  v_pk_mul_f32 v[138:139], v[138:139], v[26:27]
  v_pk_mul_f32 v[140:141], v[140:141], v[28:29]
  v_pk_mul_f32 v[142:143], v[142:143], v[30:31]
  v_exp_f32 v136, v136
  v_exp_f32 v137, v137
  v_exp_f32 v138, v138
  v_exp_f32 v139, v139
  v_exp_f32 v140, v140
  buffer_load_dwordx4 v55, s[12:15], s59 offen offset:1024 lds
  v_exp_f32 v141, v141
  v_exp_f32 v142, v142
  v_exp_f32 v143, v143
  v_pk_add_f32 v[136:137], v[136:137], 1.0 op_sel_hi:[1,0]
  v_pk_add_f32 v[138:139], v[138:139], 1.0 op_sel_hi:[1,0]
  v_pk_add_f32 v[140:141], v[140:141], 1.0 op_sel_hi:[1,0]
  v_pk_add_f32 v[142:143], v[142:143], 1.0 op_sel_hi:[1,0]
  v_rcp_f32 v136, v136
  v_rcp_f32 v137, v137
  v_rcp_f32 v138, v138
  v_rcp_f32 v139, v139
  buffer_load_dwordx4 v4, s[12:15], s59 offen offset:2048 lds
  v_rcp_f32 v140, v140
  v_rcp_f32 v141, v141
  v_rcp_f32 v142, v142
  v_rcp_f32 v143, v143
  v_pk_mul_f32 v[24:25], v[24:25], v[136:137]
  v_pk_mul_f32 v[26:27], v[26:27], v[138:139]
  v_pk_mul_f32 v[28:29], v[28:29], v[140:141]
  v_pk_mul_f32 v[30:31], v[30:31], v[142:143]
  v_pk_mul_f32 v[136:137], v[32:33], v[32:33]
  v_pk_mul_f32 v[138:139], v[34:35], v[34:35]
  v_pk_mul_f32 v[140:141], v[36:37], v[36:37]
  v_pk_mul_f32 v[142:143], v[38:39], v[38:39]
  v_pk_fma_f32 v[136:137], v[136:137], v[62:63], v[60:61]
  buffer_load_dwordx4 v55, s[12:15], s59 offen offset:3072 lds
  v_pk_fma_f32 v[138:139], v[138:139], v[62:63], v[60:61]
  v_pk_fma_f32 v[140:141], v[140:141], v[62:63], v[60:61]
  v_pk_fma_f32 v[142:143], v[142:143], v[62:63], v[60:61]
  v_pk_mul_f32 v[136:137], v[136:137], v[32:33]
  v_pk_mul_f32 v[138:139], v[138:139], v[34:35]
  v_pk_mul_f32 v[140:141], v[140:141], v[36:37]
  v_pk_mul_f32 v[142:143], v[142:143], v[38:39]
  v_exp_f32 v136, v136
  v_exp_f32 v137, v137
  s_add_u32 m0, s7, 32768
  s_xor_b32 s59, s100, 147584
  v_exp_f32 v138, v138
  v_exp_f32 v139, v139
  buffer_load_dwordx4 v4, s[12:15], s59 offen offset:0 lds
  v_exp_f32 v140, v140
  v_exp_f32 v141, v141
  v_exp_f32 v142, v142
  v_exp_f32 v143, v143
  v_pk_add_f32 v[136:137], v[136:137], 1.0 op_sel_hi:[1,0]
  v_pk_add_f32 v[138:139], v[138:139], 1.0 op_sel_hi:[1,0]
  v_pk_add_f32 v[140:141], v[140:141], 1.0 op_sel_hi:[1,0]
  v_pk_add_f32 v[142:143], v[142:143], 1.0 op_sel_hi:[1,0]
  v_rcp_f32 v136, v136
  v_rcp_f32 v137, v137
  v_rcp_f32 v138, v138
  buffer_load_dwordx4 v55, s[12:15], s59 offen offset:1024 lds
  v_rcp_f32 v139, v139
  v_rcp_f32 v140, v140
  v_rcp_f32 v141, v141
  v_rcp_f32 v142, v142
  v_rcp_f32 v143, v143
  v_pk_mul_f32 v[32:33], v[32:33], v[136:137]
  v_pk_mul_f32 v[34:35], v[34:35], v[138:139]
  v_pk_mul_f32 v[36:37], v[36:37], v[140:141]
  v_pk_mul_f32 v[38:39], v[38:39], v[142:143]
  v_pk_add_f32 v[144:145], v[16:17], v[20:21]
  v_pk_mul_f32 v[152:153], v[16:17], v[16:17]
  v_pk_add_f32 v[146:147], v[18:19], v[22:23]
  v_pk_mul_f32 v[154:155], v[18:19], v[18:19]
  buffer_load_dwordx4 v4, s[12:15], s59 offen offset:2048 lds
  v_pk_add_f32 v[148:149], v[28:29], v[32:33]
  v_pk_mul_f32 v[156:157], v[28:29], v[28:29]
  v_pk_add_f32 v[150:151], v[30:31], v[34:35]
  v_pk_mul_f32 v[158:159], v[30:31], v[30:31]
  v_pk_add_f32 v[144:145], v[144:145], v[24:25]
  v_pk_fma_f32 v[152:153], v[20:21], v[20:21], v[152:153]
  v_pk_add_f32 v[146:147], v[146:147], v[26:27]
  v_pk_fma_f32 v[154:155], v[22:23], v[22:23], v[154:155]
  v_pk_add_f32 v[148:149], v[148:149], v[36:37]
  v_pk_fma_f32 v[156:157], v[32:33], v[32:33], v[156:157]
  v_pk_add_f32 v[150:151], v[150:151], v[38:39]
  v_pk_fma_f32 v[158:159], v[34:35], v[34:35], v[158:159]
  v_pk_fma_f32 v[152:153], v[24:25], v[24:25], v[152:153]
  v_pk_fma_f32 v[154:155], v[26:27], v[26:27], v[154:155]
  v_pk_fma_f32 v[156:157], v[36:37], v[36:37], v[156:157]
  v_pk_fma_f32 v[158:159], v[38:39], v[38:39], v[158:159]
  v_add_f32_dpp v160, v144, v144 row_ror:8 row_mask:0xf bank_mask:0x3
  buffer_load_dwordx4 v55, s[12:15], s59 offen offset:3072 lds
  v_add_f32_dpp v161, v145, v145 row_ror:8 row_mask:0xf bank_mask:0x3
  v_add_f32_dpp v162, v148, v148 row_ror:8 row_mask:0xf bank_mask:0x3
  v_add_f32_dpp v163, v149, v149 row_ror:8 row_mask:0xf bank_mask:0x3
  v_add_f32_dpp v164, v152, v152 row_ror:8 row_mask:0xf bank_mask:0x3
  v_add_f32_dpp v165, v153, v153 row_ror:8 row_mask:0xf bank_mask:0x3
  v_add_f32_dpp v166, v156, v156 row_ror:8 row_mask:0xf bank_mask:0x3
  v_add_f32_dpp v167, v157, v157 row_ror:8 row_mask:0xf bank_mask:0x3
  v_add_f32_dpp v160, v146, v146 row_ror:8 row_mask:0xf bank_mask:0xc
  v_add_f32_dpp v161, v147, v147 row_ror:8 row_mask:0xf bank_mask:0xc
  v_add_f32_dpp v162, v150, v150 row_ror:8 row_mask:0xf bank_mask:0xc
  v_add_f32_dpp v163, v151, v151 row_ror:8 row_mask:0xf bank_mask:0xc
  s_add_u32 m0, s7, 49152
  s_xor_b32 s59, s100, 148480
  v_add_f32_dpp v164, v154, v154 row_ror:8 row_mask:0xf bank_mask:0xc
  v_add_f32_dpp v165, v155, v155 row_ror:8 row_mask:0xf bank_mask:0xc
  v_add_f32_dpp v166, v158, v158 row_ror:8 row_mask:0xf bank_mask:0xc
  v_add_f32_dpp v167, v159, v159 row_ror:8 row_mask:0xf bank_mask:0xc
  buffer_load_dwordx4 v4, s[12:15], s59 offen offset:0 lds
  v_add_f32_dpp v168, v160, v160 row_half_mirror row_mask:0xf bank_mask:0x5
  s_waitcnt vmcnt(9)
  s_nop 0
  v_add_f32_dpp v169, v162, v162 row_half_mirror row_mask:0xf bank_mask:0x5
  ds_read_b128 a[12:15], v5 offset:0
  v_add_f32_dpp v170, v164, v164 row_half_mirror row_mask:0xf bank_mask:0x5
  v_add_f32_dpp v171, v166, v166 row_half_mirror row_mask:0xf bank_mask:0x5
  v_add_f32_dpp v168, v161, v161 row_half_mirror row_mask:0xf bank_mask:0xa
  v_add_f32_dpp v169, v163, v163 row_half_mirror row_mask:0xf bank_mask:0xa
  v_add_f32_dpp v170, v165, v165 row_half_mirror row_mask:0xf bank_mask:0xa
  v_add_f32_dpp v171, v167, v167 row_half_mirror row_mask:0xf bank_mask:0xa
  v_add_f32_dpp v168, v168, v168 quad_perm:[1,0,3,2] row_mask:0xf bank_mask:0xf
  v_add_f32_dpp v169, v169, v169 quad_perm:[1,0,3,2] row_mask:0xf bank_mask:0xf
  v_add_f32_dpp v170, v170, v170 quad_perm:[1,0,3,2] row_mask:0xf bank_mask:0xf
  v_add_f32_dpp v171, v171, v171 quad_perm:[1,0,3,2] row_mask:0xf bank_mask:0xf
  v_add_f32_dpp v168, v168, v168 quad_perm:[2,3,0,1] row_mask:0xf bank_mask:0xf
  v_add_f32_dpp v169, v169, v169 quad_perm:[2,3,0,1] row_mask:0xf bank_mask:0xf
  v_add_f32_dpp v170, v170, v170 quad_perm:[2,3,0,1] row_mask:0xf bank_mask:0xf
  buffer_load_dwordx4 v55, s[12:15], s59 offen offset:1024 lds
  v_add_f32_dpp v171, v171, v171 quad_perm:[2,3,0,1] row_mask:0xf bank_mask:0xf
  ds_read_b128 a[28:31], v5 offset:1024
  s_waitcnt vmcnt(16)
  s_mov_b64 exec, s[44:45]
  buffer_store_dwordx4 v[168:171], v12, s[8:11], s36 offen sc1
  s_mov_b64 exec, -1
  s_or_b32 s36, s2, s34
  s_cbranch_scc1 ep_skip
  s_mov_b32 s36, 15040512
  v_mov_b32 v14, 0
  v_mov_b32 v15, s4
  s_mov_b64 exec, 1
  buffer_store_dword v15, v14, s[8:11], s36 offen sc1
  s_mov_b64 exec, -1
ep_skip:
  buffer_load_dwordx4 v4, s[12:15], s59 offen offset:2048 lds
  ds_read_b128 a[140:143], v5 offset:2048
  buffer_load_dwordx4 v55, s[12:15], s59 offen offset:3072 lds
  ds_read_b128 a[156:159], v5 offset:3072
  s_lshl3_add_u32 s46, s57, s34
  s_lshl_b32 s46, s46, 12
  s_add_u32 s46, s46, 13402112
  s_add_u32 s47, s7, 32768
  s_waitcnt vmcnt(22)
  s_barrier
  v_add_u32 v6, 49152, v0
  ds_read_b128 v[200:203], v0 offset:0
  ds_read_b128 v[204:207], v0 offset:1024
  ds_read_b128 v[208:211], v0 offset:2048
  ds_read_b128 v[212:215], v0 offset:3072
  ds_read_b128 v[216:219], v0 offset:4096
  ds_read_b128 v[220:223], v0 offset:5120
  ds_read_b128 v[224:227], v0 offset:6144
  ds_read_b128 v[228:231], v0 offset:7168
  ds_read_b128 v[232:235], v0 offset:8192
  ds_read_b128 v[236:239], v0 offset:9216
  ds_read_b128 v[240:243], v0 offset:10240
  ds_read_b128 v[244:247], v0 offset:11264
  ds_read_b128 v[248:251], v0 offset:12288
  s_mul_i32 s62, s57, 90112
  s_lshl_b32 s63, s34, 12
  s_add_u32 s62, s62, s63
  s_add_u32 s62, s62, 13926400
  s_waitcnt lgkmcnt(11)
  v_mfma_f32_16x16x32_bf16 v[176:179], v[200:203], v[64:67], 0
  ds_read_b128 v[252:255], v0 offset:13312
  s_waitcnt lgkmcnt(14)
  v_mfma_f32_16x16x32_bf16 v[176:179], v[204:207], v[68:71], v[176:179]
  ds_read_b128 v[200:203], v0 offset:14336
  s_waitcnt lgkmcnt(11)
  v_mfma_f32_16x16x32_bf16 v[176:179], v[208:211], v[72:75], v[176:179]
  ds_read_b128 v[204:207], v0 offset:15360
  s_add_u32 m0, s7, 0
  s_xor_b32 s59, s100, 148608
  v_mfma_f32_16x16x32_bf16 v[176:179], v[212:215], v[76:79], v[176:179]
  ds_read_b128 v[208:211], v0 offset:16384
  s_waitcnt lgkmcnt(11)
  buffer_load_dwordx4 v4, s[12:15], s59 offen offset:0 lds
  v_mfma_f32_16x16x32_bf16 v[176:179], v[216:219], v[80:83], v[176:179]
  ds_read_b128 v[212:215], v0 offset:17408
  s_waitcnt vmcnt(10)
  ds_read_b128 a[104:107], v5 offset:16384
  v_mfma_f32_16x16x32_bf16 v[176:179], v[220:223], v[84:87], v[176:179]
  ds_read_b128 v[216:219], v0 offset:18432
  s_waitcnt lgkmcnt(12)
  v_mfma_f32_16x16x32_bf16 v[176:179], v[224:227], v[88:91], v[176:179]
  ds_read_b128 v[220:223], v0 offset:19456
  v_mfma_f32_16x16x32_bf16 v[176:179], v[228:231], v[92:95], v[176:179]
  ds_read_b128 v[224:227], v0 offset:20480
  s_waitcnt lgkmcnt(12)
  buffer_load_dwordx4 v55, s[12:15], s59 offen offset:1024 lds
  v_mfma_f32_16x16x32_bf16 v[176:179], v[232:235], v[96:99], v[176:179]
  ds_read_b128 v[228:231], v0 offset:21504
  ds_read_b128 a[120:123], v5 offset:17408
  v_mfma_f32_16x16x32_bf16 v[176:179], v[236:239], v[100:103], v[176:179]
  ds_read_b128 v[232:235], v0 offset:22528
  s_waitcnt lgkmcnt(13)
  v_mfma_f32_16x16x32_bf16 v[176:179], v[240:243], v[104:107], v[176:179]
  ds_read_b128 v[236:239], v0 offset:23552
  v_mfma_f32_16x16x32_bf16 v[176:179], v[244:247], v[108:111], v[176:179]
  ds_read_b128 v[240:243], v0 offset:24576
  s_waitcnt lgkmcnt(13)
  buffer_load_dwordx4 v4, s[12:15], s59 offen offset:2048 lds
  v_mfma_f32_16x16x32_bf16 v[176:179], v[248:251], v[112:115], v[176:179]
  ds_read_b128 v[244:247], v0 offset:25600
  ds_read_b128 a[232:235], v5 offset:18432
  v_mfma_f32_16x16x32_bf16 v[176:179], v[252:255], v[116:119], v[176:179]
  ds_read_b128 v[248:251], v0 offset:26624
  s_waitcnt lgkmcnt(14)
  v_mfma_f32_16x16x32_bf16 v[176:179], v[200:203], v[120:123], v[176:179]
  ds_read_b128 v[252:255], v0 offset:27648
  v_mfma_f32_16x16x32_bf16 v[176:179], v[204:207], v[124:127], v[176:179]
  ds_read_b128 v[200:203], v0 offset:28672
  s_waitcnt lgkmcnt(14)
  buffer_load_dwordx4 v55, s[12:15], s59 offen offset:3072 lds
  v_mfma_f32_16x16x32_bf16 v[180:183], v[208:211], v[64:67], 0
  ds_read_b128 v[204:207], v0 offset:29696
  ds_read_b128 a[248:251], v5 offset:19456
  v_mfma_f32_16x16x32_bf16 v[180:183], v[212:215], v[68:71], v[180:183]
  ds_read_b128 v[208:211], v0 offset:30720
  s_waitcnt lgkmcnt(14)
  v_mfma_f32_16x16x32_bf16 v[180:183], v[216:219], v[72:75], v[180:183]
  ds_read_b128 v[212:215], v0 offset:31744
  s_waitcnt vmcnt(9)
  ds_read_b128 a[44:47], v5 offset:32768
  v_mfma_f32_16x16x32_bf16 v[180:183], v[220:223], v[76:79], v[180:183]
  ds_read_b128 v[216:219], v0 offset:32768
  s_waitcnt lgkmcnt(15)
  ds_read_b128 a[60:63], v5 offset:33792
  v_mfma_f32_16x16x32_bf16 v[180:183], v[224:227], v[80:83], v[180:183]
  ds_read_b128 v[220:223], v0 offset:33792
  ds_read_b128 a[172:175], v5 offset:34816
  v_mfma_f32_16x16x32_bf16 v[180:183], v[228:231], v[84:87], v[180:183]
  ds_read_b128 v[224:227], v0 offset:34816
  s_waitcnt lgkmcnt(15)
  ds_read_b128 a[188:191], v5 offset:35840
  v_mfma_f32_16x16x32_bf16 v[180:183], v[232:235], v[88:91], v[180:183]
  ds_read_b128 v[228:231], v0 offset:35840
  s_waitcnt vmcnt(4)
  ds_read_b128 a[76:79], v5 offset:49152
  v_mfma_f32_16x16x32_bf16 v[180:183], v[236:239], v[92:95], v[180:183]
  ds_read_b128 v[232:235], v0 offset:36864
  s_waitcnt lgkmcnt(15)
  ds_read_b128 a[92:95], v5 offset:50176
  v_mfma_f32_16x16x32_bf16 v[180:183], v[240:243], v[96:99], v[180:183]
  ds_read_b128 v[236:239], v0 offset:37888
  ds_read_b128 a[204:207], v5 offset:51200
  v_mfma_f32_16x16x32_bf16 v[180:183], v[244:247], v[100:103], v[180:183]
  ds_read_b128 v[240:243], v0 offset:38912
  s_waitcnt lgkmcnt(15)
  ds_read_b128 a[220:223], v5 offset:52224
  v_mfma_f32_16x16x32_bf16 v[180:183], v[248:251], v[104:107], v[180:183]
  ds_read_b128 v[244:247], v0 offset:39936
  s_waitcnt vmcnt(0)
  ds_read_b128 a[108:111], v5 offset:0
  v_mfma_f32_16x16x32_bf16 v[180:183], v[252:255], v[108:111], v[180:183]
  ds_read_b128 v[248:251], v0 offset:40960
  s_waitcnt lgkmcnt(15)
  ds_read_b128 a[124:127], v5 offset:1024
  v_mfma_f32_16x16x32_bf16 v[180:183], v[200:203], v[112:115], v[180:183]
  ds_read_b128 v[252:255], v0 offset:41984
  ds_read_b128 a[236:239], v5 offset:2048
  v_mfma_f32_16x16x32_bf16 v[180:183], v[204:207], v[116:119], v[180:183]
  ds_read_b128 v[200:203], v0 offset:43008
  s_waitcnt lgkmcnt(15)
  ds_read_b128 a[252:255], v5 offset:3072
  v_mfma_f32_16x16x32_bf16 v[180:183], v[208:211], v[120:123], v[180:183]
  ds_read_b128 v[204:207], v0 offset:44032
  buffer_load_dwordx4 v[144:147], v0, s[8:11], s39 offen offset:0 sc1
  v_mfma_f32_16x16x32_bf16 v[180:183], v[212:215], v[124:127], v[180:183]
  ds_read_b128 v[208:211], v0 offset:45056
  s_waitcnt lgkmcnt(15)
  v_mfma_f32_16x16x32_bf16 v[184:187], v[216:219], v[64:67], 0
  ds_read_b128 v[212:215], v0 offset:46080
  v_mfma_f32_16x16x32_bf16 v[184:187], v[220:223], v[68:71], v[184:187]
  ds_read_b128 v[216:219], v0 offset:47104
  buffer_load_dwordx4 v[148:151], v0, s[8:11], s39 offen offset:1024 sc1
  s_waitcnt lgkmcnt(15)
  v_mfma_f32_16x16x32_bf16 v[184:187], v[224:227], v[72:75], v[184:187]
  ds_read_b128 v[220:223], v0 offset:48128
  v_mfma_f32_16x16x32_bf16 v[184:187], v[228:231], v[76:79], v[184:187]
  ds_read_b128 v[224:227], v6 offset:0
  s_waitcnt lgkmcnt(15)
  v_mfma_f32_16x16x32_bf16 v[184:187], v[232:235], v[80:83], v[184:187]
  ds_read_b128 v[228:231], v6 offset:1024
  buffer_load_dwordx4 v[152:155], v0, s[8:11], s39 offen offset:2048 sc1
  v_mfma_f32_16x16x32_bf16 v[184:187], v[236:239], v[84:87], v[184:187]
  ds_read_b128 v[232:235], v6 offset:2048
  s_waitcnt lgkmcnt(15)
  v_mfma_f32_16x16x32_bf16 v[184:187], v[240:243], v[88:91], v[184:187]
  ds_read_b128 v[236:239], v6 offset:3072
  v_mfma_f32_16x16x32_bf16 v[184:187], v[244:247], v[92:95], v[184:187]
  ds_read_b128 v[240:243], v6 offset:4096
  buffer_load_dwordx4 v[156:159], v0, s[8:11], s39 offen offset:3072 sc1
  s_waitcnt lgkmcnt(13)
  v_mfma_f32_16x16x32_bf16 v[184:187], v[248:251], v[96:99], v[184:187]
  ds_read_b128 v[244:247], v6 offset:5120
  v_mfma_f32_16x16x32_bf16 v[184:187], v[252:255], v[100:103], v[184:187]
  ds_read_b128 v[248:251], v6 offset:6144
  s_waitcnt lgkmcnt(11)
  v_mfma_f32_16x16x32_bf16 v[184:187], v[200:203], v[104:107], v[184:187]
  ds_read_b128 v[252:255], v6 offset:7168
  s_waitcnt lgkmcnt(13)
  v_mfma_f32_16x16x32_bf16 v[184:187], v[204:207], v[108:111], v[184:187]
  ds_read_b128 v[200:203], v6 offset:8192
  s_waitcnt lgkmcnt(11)
  v_mfma_f32_16x16x32_bf16 v[184:187], v[208:211], v[112:115], v[184:187]
  ds_read_b128 v[204:207], v6 offset:9216
  s_add_u32 m0, s47, 0
  s_add_u32 s59, s46, 0
  v_mfma_f32_16x16x32_bf16 v[184:187], v[212:215], v[116:119], v[184:187]
  ds_read_b128 v[208:211], v6 offset:10240
  s_waitcnt lgkmcnt(11)
  buffer_load_dwordx4 v0, s[8:11], s59 offen offset:0 sc1 lds
  v_mfma_f32_16x16x32_bf16 v[184:187], v[216:219], v[120:123], v[184:187]
  ds_read_b128 v[212:215], v6 offset:11264
  v_mfma_f32_16x16x32_bf16 v[184:187], v[220:223], v[124:127], v[184:187]
  ds_read_b128 v[216:219], v6 offset:12288
  s_waitcnt lgkmcnt(11)
  s_barrier
  v_mfma_f32_16x16x32_bf16 v[188:191], v[224:227], v[64:67], 0
  ds_read_b128 v[220:223], v6 offset:13312
  v_mfma_f32_16x16x32_bf16 v[188:191], v[228:231], v[68:71], v[188:191]
  ds_read_b128 v[224:227], v6 offset:14336
  s_waitcnt lgkmcnt(11)
  buffer_load_dwordx4 v0, s[8:11], s59 offen offset:1024 sc1 lds
  v_mfma_f32_16x16x32_bf16 v[188:191], v[232:235], v[72:75], v[188:191]
  ds_read_b128 v[228:231], v6 offset:15360
  v_mfma_f32_16x16x32_bf16 v[188:191], v[236:239], v[76:79], v[188:191]
  ds_read_b128 v[232:235], v6 offset:16384
  s_waitcnt lgkmcnt(11)
  v_mfma_f32_16x16x32_bf16 v[188:191], v[240:243], v[80:83], v[188:191]
  ds_read_b128 v[236:239], v6 offset:17408
  v_mfma_f32_16x16x32_bf16 v[188:191], v[244:247], v[84:87], v[188:191]
  ds_read_b128 v[240:243], v6 offset:18432
  s_waitcnt lgkmcnt(11)
  buffer_load_dwordx4 v0, s[8:11], s59 offen offset:2048 sc1 lds
  v_mfma_f32_16x16x32_bf16 v[188:191], v[248:251], v[88:91], v[188:191]
  ds_read_b128 v[244:247], v6 offset:19456
  v_mfma_f32_16x16x32_bf16 v[188:191], v[252:255], v[92:95], v[188:191]
  ds_read_b128 v[248:251], v6 offset:20480
  s_waitcnt lgkmcnt(11)
  v_mfma_f32_16x16x32_bf16 v[188:191], v[200:203], v[96:99], v[188:191]
  ds_read_b128 v[252:255], v6 offset:21504
  v_mfma_f32_16x16x32_bf16 v[188:191], v[204:207], v[100:103], v[188:191]
  ds_read_b128 v[200:203], v6 offset:22528
  s_waitcnt lgkmcnt(11)
  buffer_load_dwordx4 v0, s[8:11], s59 offen offset:3072 sc1 lds
  v_mfma_f32_16x16x32_bf16 v[188:191], v[208:211], v[104:107], v[188:191]
  ds_read_b128 v[204:207], v6 offset:23552
  v_mfma_f32_16x16x32_bf16 v[188:191], v[212:215], v[108:111], v[188:191]
  ds_read_b128 v[208:211], v6 offset:24576
  s_waitcnt vmcnt(4)
  v_max3_u32 v15, v144, v148, v152
  v_max3_u32 v15, v15, v156, v147
  v_max3_u32 v15, v15, v151, v155
  v_max_u32 v15, v15, v159
  v_cmp_eq_u32 vcc, -1, v15
  s_nop 3
  s_cbranch_vccnz st_slow
st_ok:
  v_pk_add_f32 v[144:145], v[144:145], v[148:149]
  v_pk_add_f32 v[152:153], v[152:153], v[156:157]
  v_pk_add_f32 v[146:147], v[146:147], v[150:151]
  v_pk_add_f32 v[154:155], v[154:155], v[158:159]
  v_mov_b32 v57, 0x3abe82fa
  v_pk_add_f32 v[144:145], v[144:145], v[152:153]
  v_pk_add_f32 v[146:147], v[146:147], v[154:155]
  v_mov_b32 v148, v59
  v_mov_b32 v149, v59
  v_mov_b32 v150, v59
  v_mov_b32 v151, v59
  v_mfma_f32_16x16x4_f32 v[152:155], v144, v57, 0
  s_nop 0
  v_mfma_f32_16x16x4_f32 v[160:163], v146, v57, v[148:151]
  v_mfma_f32_16x16x4_f32 v[156:159], v145, v57, 0
  v_mfma_f32_16x16x4_f32 v[164:167], v147, v57, v[148:151]
  s_mul_i32 s36, s40, 3
  s_lshl1_add_u32 s36, s98, s36
  s_lshl_b32 s36, s36, 6
  s_add_u32 s36, s36, s38
  s_lshl_b32 s36, s36, 10
  s_nop 2
  v_pk_fma_f32 v[160:161], v[152:153], v[152:153], v[160:161] neg_lo:[1,0,0] neg_hi:[1,0,0]
  v_pk_fma_f32 v[162:163], v[154:155], v[154:155], v[162:163] neg_lo:[1,0,0] neg_hi:[1,0,0]
  v_max_f32 v160, v59, v160
  v_max_f32 v161, v59, v161
  v_max_f32 v162, v59, v162
  v_max_f32 v163, v59, v163
  v_rsq_f32 v160, v160
  v_rsq_f32 v161, v161
  v_rsq_f32 v162, v162
  v_rsq_f32 v163, v163
  v_pk_fma_f32 v[164:165], v[156:157], v[156:157], v[164:165] neg_lo:[1,0,0] neg_hi:[1,0,0]
  v_pk_fma_f32 v[166:167], v[158:159], v[158:159], v[166:167] neg_lo:[1,0,0] neg_hi:[1,0,0]
  v_max_f32 v164, v59, v164
  v_max_f32 v165, v59, v165
  v_max_f32 v166, v59, v166
  v_max_f32 v167, v59, v167
  v_rsq_f32 v164, v164
  v_rsq_f32 v165, v165
  v_rsq_f32 v166, v166
  v_rsq_f32_e64 v167, v167
  v_pk_mul_f32 v[152:153], v[152:153], v[160:161]
  v_pk_mul_f32 v[154:155], v[154:155], v[162:163]
  v_pk_mul_f32 v[156:157], v[156:157], v[164:165]
  v_pk_mul_f32 v[158:159], v[158:159], v[166:167]
  v_pk_fma_f32 v[16:17], v[16:17], v[160:161], v[152:153] neg_lo:[0,0,1] neg_hi:[0,0,1]
  v_pk_fma_f32 v[18:19], v[18:19], v[162:163], v[154:155] neg_lo:[0,0,1] neg_hi:[0,0,1]
  v_pk_fma_f32 v[28:29], v[28:29], v[164:165], v[156:157] neg_lo:[0,0,1] neg_hi:[0,0,1]
  v_pk_fma_f32 v[30:31], v[30:31], v[166:167], v[158:159] neg_lo:[0,0,1] neg_hi:[0,0,1]
  v_cvt_pk_bf16_f32 v40, v16, v17
  v_cvt_pk_bf16_f32 v41, v18, v19
  v_cvt_pk_bf16_f32 v42, v28, v29
  v_cvt_pk_bf16_f32 v43, v30, v31
  buffer_store_dwordx4 v[40:43], v0, s[24:27], s36 offen sc1
  s_add_u32 s36, s36, 65536
  v_pk_fma_f32 v[20:21], v[20:21], v[160:161], v[152:153] neg_lo:[0,0,1] neg_hi:[0,0,1]
  v_pk_fma_f32 v[22:23], v[22:23], v[162:163], v[154:155] neg_lo:[0,0,1] neg_hi:[0,0,1]
  v_pk_fma_f32 v[32:33], v[32:33], v[164:165], v[156:157] neg_lo:[0,0,1] neg_hi:[0,0,1]
  v_pk_fma_f32 v[34:35], v[34:35], v[166:167], v[158:159] neg_lo:[0,0,1] neg_hi:[0,0,1]
  v_cvt_pk_bf16_f32 v44, v20, v21
  v_cvt_pk_bf16_f32 v45, v22, v23
  v_cvt_pk_bf16_f32 v46, v32, v33
  v_cvt_pk_bf16_f32 v47, v34, v35
  buffer_store_dwordx4 v[44:47], v0, s[24:27], s36 offen sc1
  s_add_u32 s36, s36, 65536
  v_pk_fma_f32 v[24:25], v[24:25], v[160:161], v[152:153] neg_lo:[0,0,1] neg_hi:[0,0,1]
  v_pk_fma_f32 v[26:27], v[26:27], v[162:163], v[154:155] neg_lo:[0,0,1] neg_hi:[0,0,1]
  v_pk_fma_f32 v[36:37], v[36:37], v[164:165], v[156:157] neg_lo:[0,0,1] neg_hi:[0,0,1]
  v_pk_fma_f32 v[38:39], v[38:39], v[166:167], v[158:159] neg_lo:[0,0,1] neg_hi:[0,0,1]
  v_cvt_pk_bf16_f32 v48, v24, v25
  v_cvt_pk_bf16_f32 v49, v26, v27
  v_cvt_pk_bf16_f32 v50, v36, v37
  v_cvt_pk_bf16_f32 v51, v38, v39
  buffer_store_dwordx4 v[48:51], v0, s[24:27], s36 offen sc1
  s_add_u32 s36, s36, 65536
  v_mfma_f32_16x16x4_f32 v[128:131], v58, v56, 0
  s_waitcnt lgkmcnt(11)
  s_waitcnt lgkmcnt(15)
  s_add_u32 m0, s47, 16384
  s_add_u32 s59, s46, 16384
  v_mfma_f32_16x16x32_bf16 v[188:191], v[216:219], v[112:115], v[188:191]
  ds_read_b128 v[212:215], v6 offset:25600
  buffer_load_dwordx4 v0, s[8:11], s59 offen offset:0 sc1 lds
  v_mfma_f32_16x16x32_bf16 v[188:191], v[220:223], v[116:119], v[188:191]
  ds_read_b128 v[216:219], v6 offset:26624
  s_waitcnt lgkmcnt(11)
  v_mfma_f32_16x16x32_bf16 v[188:191], v[224:227], v[120:123], v[188:191]
  ds_read_b128 v[220:223], v6 offset:27648
  v_mfma_f32_16x16x32_bf16 v[188:191], v[228:231], v[124:127], v[188:191]
  ds_read_b128 v[224:227], v6 offset:28672
  s_waitcnt lgkmcnt(11)
  v_mfma_f32_16x16x32_bf16 v[192:195], v[232:235], v[64:67], 0
  ds_read_b128 v[228:231], v6 offset:29696
  buffer_load_dwordx4 v0, s[8:11], s59 offen offset:1024 sc1 lds
  v_mfma_f32_16x16x32_bf16 v[192:195], v[236:239], v[68:71], v[192:195]
  ds_read_b128 v[232:235], v6 offset:30720
  s_waitcnt lgkmcnt(11)
  v_mfma_f32_16x16x32_bf16 v[192:195], v[240:243], v[72:75], v[192:195]
  ds_read_b128 v[236:239], v6 offset:31744
  v_mfma_f32_16x16x32_bf16 v[192:195], v[244:247], v[76:79], v[192:195]
  ds_read_b128 v[240:243], v6 offset:32768
  s_waitcnt lgkmcnt(11)
  v_mfma_f32_16x16x32_bf16 v[192:195], v[248:251], v[80:83], v[192:195]
  ds_read_b128 v[244:247], v6 offset:33792
  buffer_load_dwordx4 v0, s[8:11], s59 offen offset:2048 sc1 lds
  v_mfma_f32_16x16x32_bf16 v[192:195], v[252:255], v[84:87], v[192:195]
  ds_read_b128 v[248:251], v6 offset:34816
  s_waitcnt lgkmcnt(11)
  v_mfma_f32_16x16x32_bf16 v[192:195], v[200:203], v[88:91], v[192:195]
  ds_read_b128 v[252:255], v6 offset:35840
  v_mfma_f32_16x16x32_bf16 v[192:195], v[204:207], v[92:95], v[192:195]
  ds_read_b128 v[200:203], v6 offset:36864
  s_waitcnt lgkmcnt(11)
  v_mfma_f32_16x16x32_bf16 v[192:195], v[208:211], v[96:99], v[192:195]
  ds_read_b128 v[204:207], v6 offset:37888
  buffer_load_dwordx4 v0, s[8:11], s59 offen offset:3072 sc1 lds
  v_mfma_f32_16x16x32_bf16 v[192:195], v[212:215], v[100:103], v[192:195]
  ds_read_b128 v[208:211], v6 offset:38912
  s_waitcnt lgkmcnt(11)
  v_mfma_f32_16x16x32_bf16 v[192:195], v[216:219], v[104:107], v[192:195]
  ds_read_b128 v[212:215], v6 offset:39936
  v_mfma_f32_16x16x32_bf16 v[192:195], v[220:223], v[108:111], v[192:195]
  ds_read_b128 v[216:219], v6 offset:40960
  s_waitcnt lgkmcnt(11)
  v_mfma_f32_16x16x32_bf16 v[192:195], v[224:227], v[112:115], v[192:195]
  ds_read_b128 v[220:223], v6 offset:41984
  s_add_u32 m0, s63, 0
  s_add_u32 s59, s62, 0
  v_mfma_f32_16x16x32_bf16 v[192:195], v[228:231], v[116:119], v[192:195]
  ds_read_b128 v[224:227], v6 offset:43008
  s_waitcnt lgkmcnt(11)
  buffer_load_dwordx4 v0, s[8:11], s59 offen offset:0 sc1 lds
  v_mfma_f32_16x16x32_bf16 v[192:195], v[232:235], v[120:123], v[192:195]
  ds_read_b128 v[228:231], v6 offset:44032
  v_mfma_f32_16x16x32_bf16 v[192:195], v[236:239], v[124:127], v[192:195]
  ds_read_b128 v[232:235], v6 offset:45056
  s_waitcnt lgkmcnt(11)
  v_mfma_f32_16x16x32_bf16 v[196:199], v[240:243], v[64:67], 0
  ds_read_b128 v[236:239], v6 offset:46080
  v_mfma_f32_16x16x32_bf16 v[196:199], v[244:247], v[68:71], v[196:199]
  ds_read_b128 v[240:243], v6 offset:47104
  s_waitcnt lgkmcnt(11)
  buffer_load_dwordx4 v0, s[8:11], s59 offen offset:1024 sc1 lds
  v_mfma_f32_16x16x32_bf16 v[196:199], v[248:251], v[72:75], v[196:199]
  ds_read_b128 v[244:247], v6 offset:48128
  v_mfma_f32_16x16x32_bf16 v[196:199], v[252:255], v[76:79], v[196:199]
  s_waitcnt lgkmcnt(10)
  v_mfma_f32_16x16x32_bf16 v[196:199], v[200:203], v[80:83], v[196:199]
  v_mfma_f32_16x16x32_bf16 v[196:199], v[204:207], v[84:87], v[196:199]
  s_waitcnt lgkmcnt(8)
  buffer_load_dwordx4 v0, s[8:11], s59 offen offset:2048 sc1 lds
  v_mfma_f32_16x16x32_bf16 v[196:199], v[208:211], v[88:91], v[196:199]
  v_mfma_f32_16x16x32_bf16 v[196:199], v[212:215], v[92:95], v[196:199]
  s_waitcnt lgkmcnt(6)
  v_mfma_f32_16x16x32_bf16 v[196:199], v[216:219], v[96:99], v[196:199]
  v_mfma_f32_16x16x32_bf16 v[196:199], v[220:223], v[100:103], v[196:199]
  s_waitcnt lgkmcnt(4)
  buffer_load_dwordx4 v0, s[8:11], s59 offen offset:3072 sc1 lds
  v_mfma_f32_16x16x32_bf16 v[196:199], v[224:227], v[104:107], v[196:199]
  v_mfma_f32_16x16x32_bf16 v[196:199], v[228:231], v[108:111], v[196:199]
  s_waitcnt lgkmcnt(2)
  v_mfma_f32_16x16x32_bf16 v[196:199], v[232:235], v[112:115], v[196:199]
  s_add_u32 m0, s63, 16384
  s_add_u32 s59, s62, 16384
  v_mfma_f32_16x16x32_bf16 v[196:199], v[236:239], v[116:119], v[196:199]
  s_waitcnt lgkmcnt(0)
  buffer_load_dwordx4 v0, s[8:11], s59 offen offset:0 sc1 lds
  v_mfma_f32_16x16x32_bf16 v[196:199], v[240:243], v[120:123], v[196:199]
  v_mfma_f32_16x16x32_bf16 v[196:199], v[244:247], v[124:127], v[196:199]
  s_barrier
  v_pk_mul_f32 v[176:177], v[176:177], v[128:129]
  v_pk_mul_f32 v[178:179], v[178:179], v[128:129]
  v_pk_mul_f32 v[180:181], v[180:181], v[128:129]
  v_pk_mul_f32 v[182:183], v[182:183], v[128:129]
  v_pk_mul_f32 v[184:185], v[184:185], v[128:129]
  v_pk_mul_f32 v[186:187], v[186:187], v[128:129]
  v_pk_mul_f32 v[188:189], v[188:189], v[128:129]
  v_pk_mul_f32 v[190:191], v[190:191], v[128:129]
  buffer_load_dwordx4 v0, s[8:11], s59 offen offset:1024 sc1 lds
  v_pk_mul_f32 v[192:193], v[192:193], v[128:129]
  v_pk_mul_f32 v[194:195], v[194:195], v[128:129]
  v_pk_mul_f32 v[196:197], v[196:197], v[128:129]
  v_pk_mul_f32 v[198:199], v[198:199], v[128:129]
  s_waitcnt vmcnt(10)
  v_mov_b32 v14, 0
  v_mov_b32 v15, s4
  s_mov_b64 exec, 1
  buffer_store_dword v15, v14, s[8:11], s37 offen sc1
  s_mov_b64 exec, -1
  s_nop 0
  v_pk_mul_f32 v[136:137], v[176:177], v[176:177]
  v_pk_mul_f32 v[138:139], v[178:179], v[178:179]
  v_pk_mul_f32 v[140:141], v[180:181], v[180:181]
  v_pk_mul_f32 v[142:143], v[182:183], v[182:183]
  v_pk_fma_f32 v[136:137], v[136:137], v[62:63], v[60:61]
  v_pk_fma_f32 v[138:139], v[138:139], v[62:63], v[60:61]
  v_pk_fma_f32 v[140:141], v[140:141], v[62:63], v[60:61]
  buffer_load_dwordx4 v0, s[8:11], s59 offen offset:2048 sc1 lds
  v_pk_fma_f32 v[142:143], v[142:143], v[62:63], v[60:61]
  v_pk_mul_f32 v[136:137], v[136:137], v[176:177]
  v_pk_mul_f32 v[138:139], v[138:139], v[178:179]
  v_pk_mul_f32 v[140:141], v[140:141], v[180:181]
  v_pk_mul_f32 v[142:143], v[142:143], v[182:183]
  v_exp_f32 v136, v136
  v_exp_f32 v137, v137
  v_exp_f32 v138, v138
  v_exp_f32 v139, v139
  v_exp_f32 v140, v140
  v_exp_f32 v141, v141
  buffer_load_dwordx4 v0, s[8:11], s59 offen offset:3072 sc1 lds
  v_exp_f32 v142, v142
  v_exp_f32 v143, v143
  v_pk_add_f32 v[136:137], v[136:137], 1.0 op_sel_hi:[1,0]
  v_pk_add_f32 v[138:139], v[138:139], 1.0 op_sel_hi:[1,0]
  v_pk_add_f32 v[140:141], v[140:141], 1.0 op_sel_hi:[1,0]
  v_pk_add_f32 v[142:143], v[142:143], 1.0 op_sel_hi:[1,0]
  v_rcp_f32 v136, v136
  v_rcp_f32 v137, v137
  s_add_u32 m0, s63, 32768
  s_add_u32 s59, s62, 32768
  v_rcp_f32 v138, v138
  v_rcp_f32 v139, v139
  buffer_load_dwordx4 v0, s[8:11], s59 offen offset:0 sc1 lds
  v_rcp_f32 v140, v140
  v_rcp_f32 v141, v141
  v_rcp_f32 v142, v142
  v_rcp_f32 v143, v143
  v_pk_mul_f32 v[176:177], v[176:177], v[136:137]
  v_pk_mul_f32 v[178:179], v[178:179], v[138:139]
  v_pk_mul_f32 v[180:181], v[180:181], v[140:141]
  v_pk_mul_f32 v[182:183], v[182:183], v[142:143]
  v_pk_mul_f32 v[136:137], v[184:185], v[184:185]
  v_pk_mul_f32 v[138:139], v[186:187], v[186:187]
  v_pk_mul_f32 v[140:141], v[188:189], v[188:189]
  v_pk_mul_f32 v[142:143], v[190:191], v[190:191]
  v_pk_fma_f32 v[136:137], v[136:137], v[62:63], v[60:61]
  buffer_load_dwordx4 v0, s[8:11], s59 offen offset:1024 sc1 lds
  v_pk_fma_f32 v[138:139], v[138:139], v[62:63], v[60:61]
  v_pk_fma_f32 v[140:141], v[140:141], v[62:63], v[60:61]
  v_pk_fma_f32 v[142:143], v[142:143], v[62:63], v[60:61]
  v_pk_mul_f32 v[136:137], v[136:137], v[184:185]
  v_pk_mul_f32 v[138:139], v[138:139], v[186:187]
  v_pk_mul_f32 v[140:141], v[140:141], v[188:189]
  v_pk_mul_f32 v[142:143], v[142:143], v[190:191]
  v_exp_f32 v136, v136
  v_exp_f32 v137, v137
  v_exp_f32 v138, v138
  v_exp_f32 v139, v139
  v_exp_f32 v140, v140
  buffer_load_dwordx4 v0, s[8:11], s59 offen offset:2048 sc1 lds
  v_exp_f32 v141, v141
  v_exp_f32 v142, v142
  v_exp_f32 v143, v143
  v_pk_add_f32 v[136:137], v[136:137], 1.0 op_sel_hi:[1,0]
  v_pk_add_f32 v[138:139], v[138:139], 1.0 op_sel_hi:[1,0]
  v_pk_add_f32 v[140:141], v[140:141], 1.0 op_sel_hi:[1,0]
  v_pk_add_f32 v[142:143], v[142:143], 1.0 op_sel_hi:[1,0]
  v_rcp_f32 v136, v136
  v_rcp_f32 v137, v137
  v_rcp_f32 v138, v138
  v_rcp_f32 v139, v139
  buffer_load_dwordx4 v0, s[8:11], s59 offen offset:3072 sc1 lds
  v_rcp_f32 v140, v140
  v_rcp_f32 v141, v141
  v_rcp_f32 v142, v142
  v_rcp_f32 v143, v143
  v_pk_mul_f32 v[184:185], v[184:185], v[136:137]
  v_pk_mul_f32 v[186:187], v[186:187], v[138:139]
  v_pk_mul_f32 v[188:189], v[188:189], v[140:141]
  s_add_u32 m0, s63, 49152
  s_add_u32 s59, s62, 49152
  v_pk_mul_f32 v[190:191], v[190:191], v[142:143]
  v_pk_mul_f32 v[136:137], v[192:193], v[192:193]
  v_pk_mul_f32 v[138:139], v[194:195], v[194:195]
  v_pk_mul_f32 v[140:141], v[196:197], v[196:197]
  buffer_load_dwordx4 v0, s[8:11], s59 offen offset:0 sc1 lds
  v_pk_mul_f32 v[142:143], v[198:199], v[198:199]
  v_pk_fma_f32 v[136:137], v[136:137], v[62:63], v[60:61]
  v_pk_fma_f32 v[138:139], v[138:139], v[62:63], v[60:61]
  v_pk_fma_f32 v[140:141], v[140:141], v[62:63], v[60:61]
  v_pk_fma_f32 v[142:143], v[142:143], v[62:63], v[60:61]
  v_pk_mul_f32 v[136:137], v[136:137], v[192:193]
  v_pk_mul_f32 v[138:139], v[138:139], v[194:195]
  v_pk_mul_f32 v[140:141], v[140:141], v[196:197]
  v_pk_mul_f32 v[142:143], v[142:143], v[198:199]
  v_exp_f32 v136, v136
  v_exp_f32 v137, v137
  v_exp_f32 v138, v138
  v_exp_f32 v139, v139
  buffer_load_dwordx4 v0, s[8:11], s59 offen offset:1024 sc1 lds
  v_exp_f32 v140, v140
  v_exp_f32 v141, v141
  v_exp_f32 v142, v142
  v_exp_f32 v143, v143
  v_pk_add_f32 v[136:137], v[136:137], 1.0 op_sel_hi:[1,0]
  v_pk_add_f32 v[138:139], v[138:139], 1.0 op_sel_hi:[1,0]
  v_pk_add_f32 v[140:141], v[140:141], 1.0 op_sel_hi:[1,0]
  v_pk_add_f32 v[142:143], v[142:143], 1.0 op_sel_hi:[1,0]
  v_rcp_f32 v136, v136
  v_rcp_f32 v137, v137
  v_rcp_f32 v138, v138
  buffer_load_dwordx4 v0, s[8:11], s59 offen offset:2048 sc1 lds
  v_rcp_f32 v139, v139
  v_rcp_f32 v140, v140
  v_rcp_f32 v141, v141
  v_rcp_f32 v142, v142
  v_rcp_f32 v143, v143
  v_pk_mul_f32 v[192:193], v[192:193], v[136:137]
  v_pk_mul_f32 v[194:195], v[194:195], v[138:139]
  v_pk_mul_f32 v[196:197], v[196:197], v[140:141]
  v_pk_mul_f32 v[198:199], v[198:199], v[142:143]
  s_lshl_b32 s37, s98, 17
  s_lshl_b32 s41, s34, 12
  s_add_u32 s37, s37, s41
  v_add_u32 v7, s37, v0
  v_and_b32 v8, 24, v1
  v_and_b32 v15, 7, v1
  v_lshl_add_u32 v8, v8, 2, v15
  v_lshlrev_b32 v8, 6, v8
  s_lshl4_add_u32 s38, s57, s34
  s_lshl_b32 s38, s38, 9
  s_add_u32 s38, s38, 15175680
  v_lshlrev_b32 v12, 10, v10
  v_lshl_add_u32 v13, s34, 12, v0
  buffer_load_dwordx4 v0, s[8:11], s59 offen offset:3072 sc1 lds
  v_xor_b32 v9, 4096, v13
  v_add_u32 v9, 98304, v9
  v_xor_b32 v10, 8192, v13
  v_add_u32 v10, 99328, v10
  v_xor_b32 v11, 12288, v13
  v_add_u32 v11, 100352, v11
  v_add_u32 v13, 98304, v13
  s_lshl_b32 s41, s98, 17
  s_lshl2_add_u32 s42, s56, s34
  s_lshl_b32 s42, s42, 10
  s_add_u32 s41, s41, s42
  v_add_u32 v14, s42, v0
  v_lshl_add_u32 v12, v3, 4, v12
  s_add_u32 m0, s63, 65536
  s_add_u32 s59, s62, 65536
  buffer_load_dwordx4 v0, s[8:11], s59 offen offset:0 sc1 lds
  buffer_load_dwordx4 v0, s[8:11], s59 offen offset:1024 sc1 lds
  buffer_load_dwordx4 v0, s[8:11], s59 offen offset:2048 sc1 lds
  buffer_load_dwordx4 v0, s[8:11], s59 offen offset:3072 sc1 lds
  buffer_load_dword v40, v8, s[8:11], s38 offen sc1
  s_add_u32 m0, s63, 81920
  s_add_u32 s59, s62, 81920
  buffer_load_dwordx4 v0, s[8:11], s59 offen offset:0 sc1 lds
  buffer_load_dwordx4 v0, s[8:11], s59 offen offset:1024 sc1 lds
  buffer_load_dwordx4 v0, s[8:11], s59 offen offset:2048 sc1 lds
  buffer_load_dwordx4 v0, s[8:11], s59 offen offset:3072 sc1 lds
  s_waitcnt vmcnt(62)
  v_lshlrev_b32 v36, 16, v52
  v_mov_b32 v32, v53
  v_lshlrev_b32 v37, 16, v52
  v_mov_b32 v33, v53
  v_lshlrev_b32 v38, 16, v52
  v_mov_b32 v34, v53
  v_lshlrev_b32 v39, 16, v52
  v_mov_b32 v35, v53
  s_waitcnt vmcnt(4)
  v_cmp_ne_u32 vcc, s4, v40
  s_nop 3
  s_cbranch_vccnz z_slow
z_ok:
  v_mov_b32 v8, v7
  buffer_load_dwordx4 v[144:147], v7, s[24:27], s64 offen offset:0 sc1
  buffer_load_dwordx4 v[148:151], v7, s[24:27], s64 offen offset:1024 sc1
  buffer_load_dwordx4 v[152:155], v7, s[24:27], s65 offen offset:0 sc1
  buffer_load_dwordx4 v[156:159], v7, s[24:27], s65 offen offset:1024 sc1
  buffer_load_dwordx4 v[160:163], v7, s[24:27], s66 offen offset:0 sc1
  buffer_load_dwordx4 v[164:167], v7, s[24:27], s66 offen offset:1024 sc1
  buffer_load_dwordx4 v[168:171], v7, s[24:27], s67 offen offset:0 sc1
  buffer_load_dwordx4 v[172:175], v7, s[24:27], s67 offen offset:1024 sc1
  buffer_load_dwordx4 v[16:19], v7, s[24:27], s68 offen offset:0 sc1
  buffer_load_dwordx4 v[20:23], v7, s[24:27], s68 offen offset:1024 sc1
  v_add_u32 v6, 45056, v0
  v_add_u32 v5, 131072, v0
  s_waitcnt lgkmcnt(0)
  s_barrier
  s_waitcnt vmcnt(9)
  v_mfma_f32_16x16x32_bf16 v[200:203], v[144:147], a[0:3], v[36:39]
  buffer_load_dwordx4 v[24:27], v7, s[24:27], s69 offen offset:0 sc1
  v_mfma_f32_16x16x32_bf16 v[204:207], v[144:147], a[4:7], 0
  v_mfma_f32_16x16x32_bf16 v[208:211], v[144:147], a[8:11], 0
  buffer_load_dwordx4 v[28:31], v7, s[24:27], s69 offen offset:1024 sc1
  v_mfma_f32_16x16x32_bf16 v[212:215], v[144:147], a[12:15], 0
  s_waitcnt vmcnt(10)
  v_mfma_f32_16x16x32_bf16 v[200:203], v[148:151], a[16:19], v[200:203]
  buffer_load_dwordx4 v[128:131], v7, s[24:27], s70 offen offset:0 sc1
  v_mfma_f32_16x16x32_bf16 v[204:207], v[148:151], a[20:23], v[204:207]
  v_mfma_f32_16x16x32_bf16 v[208:211], v[148:151], a[24:27], v[208:211]
  v_mfma_f32_16x16x32_bf16 v[212:215], v[148:151], a[28:31], v[212:215]
  s_waitcnt vmcnt(10)
  v_mfma_f32_16x16x32_bf16 v[200:203], v[152:155], a[32:35], v[200:203]
  buffer_load_dwordx4 v[132:135], v7, s[24:27], s70 offen offset:1024 sc1
  v_mfma_f32_16x16x32_bf16 v[204:207], v[152:155], a[36:39], v[204:207]
  v_mfma_f32_16x16x32_bf16 v[208:211], v[152:155], a[40:43], v[208:211]
  buffer_load_dwordx4 v[136:139], v7, s[24:27], s71 offen offset:0 sc1
  v_mfma_f32_16x16x32_bf16 v[212:215], v[152:155], a[44:47], v[212:215]
  s_waitcnt vmcnt(11)
  v_mfma_f32_16x16x32_bf16 v[200:203], v[156:159], a[48:51], v[200:203]
  buffer_load_dwordx4 v[140:143], v7, s[24:27], s71 offen offset:1024 sc1
  v_add_u32 v7, 65536, v7
  v_mfma_f32_16x16x32_bf16 v[204:207], v[156:159], a[52:55], v[204:207]
  v_mfma_f32_16x16x32_bf16 v[208:211], v[156:159], a[56:59], v[208:211]
  v_mfma_f32_16x16x32_bf16 v[212:215], v[156:159], a[60:63], v[212:215]
  s_waitcnt vmcnt(11)
  v_mfma_f32_16x16x32_bf16 v[200:203], v[160:163], a[64:67], v[200:203]
  buffer_load_dwordx4 v[48:51], v7, s[24:27], s64 offen offset:0 sc1
  v_mfma_f32_16x16x32_bf16 v[204:207], v[160:163], a[68:71], v[204:207]
  v_mfma_f32_16x16x32_bf16 v[208:211], v[160:163], a[72:75], v[208:211]
  buffer_load_dwordx4 v[52:55], v7, s[24:27], s64 offen offset:1024 sc1
  v_mfma_f32_16x16x32_bf16 v[212:215], v[160:163], a[76:79], v[212:215]
  s_waitcnt vmcnt(12)
  v_mfma_f32_16x16x32_bf16 v[200:203], v[164:167], a[80:83], v[200:203]
  buffer_load_dwordx4 v[56:59], v7, s[24:27], s65 offen offset:0 sc1
  v_mfma_f32_16x16x32_bf16 v[204:207], v[164:167], a[84:87], v[204:207]
  v_mfma_f32_16x16x32_bf16 v[208:211], v[164:167], a[88:91], v[208:211]
  v_mfma_f32_16x16x32_bf16 v[212:215], v[164:167], a[92:95], v[212:215]
  s_waitcnt vmcnt(12)
  v_mfma_f32_16x16x32_bf16 v[200:203], v[168:171], a[96:99], v[200:203]
  buffer_load_dwordx4 v[60:63], v7, s[24:27], s65 offen offset:1024 sc1
  v_mfma_f32_16x16x32_bf16 v[204:207], v[168:171], a[100:103], v[204:207]
  v_mfma_f32_16x16x32_bf16 v[208:211], v[168:171], a[104:107], v[208:211]
  v_mfma_f32_16x16x32_bf16 v[212:215], v[168:171], a[108:111], v[212:215]
  s_waitcnt vmcnt(12)
  v_mfma_f32_16x16x32_bf16 v[200:203], v[172:175], a[112:115], v[200:203]
  buffer_load_dwordx4 v[144:147], v7, s[24:27], s66 offen offset:0 sc1
  v_mfma_f32_16x16x32_bf16 v[204:207], v[172:175], a[116:119], v[204:207]
  v_mfma_f32_16x16x32_bf16 v[208:211], v[172:175], a[120:123], v[208:211]
  v_mfma_f32_16x16x32_bf16 v[212:215], v[172:175], a[124:127], v[212:215]
  s_waitcnt vmcnt(12)
  v_mfma_f32_16x16x32_bf16 v[200:203], v[16:19], a[128:131], v[200:203]
  buffer_load_dwordx4 v[148:151], v7, s[24:27], s66 offen offset:1024 sc1
  v_mfma_f32_16x16x32_bf16 v[204:207], v[16:19], a[132:135], v[204:207]
  v_mfma_f32_16x16x32_bf16 v[208:211], v[16:19], a[136:139], v[208:211]
  v_mfma_f32_16x16x32_bf16 v[212:215], v[16:19], a[140:143], v[212:215]
  s_waitcnt vmcnt(12)
  v_mfma_f32_16x16x32_bf16 v[200:203], v[20:23], a[144:147], v[200:203]
  buffer_load_dwordx4 v[152:155], v7, s[24:27], s67 offen offset:0 sc1
  v_mfma_f32_16x16x32_bf16 v[204:207], v[20:23], a[148:151], v[204:207]
  v_mfma_f32_16x16x32_bf16 v[208:211], v[20:23], a[152:155], v[208:211]
  v_mfma_f32_16x16x32_bf16 v[212:215], v[20:23], a[156:159], v[212:215]
  s_waitcnt vmcnt(12)
  v_mfma_f32_16x16x32_bf16 v[200:203], v[24:27], a[160:163], v[200:203]
  buffer_load_dwordx4 v[156:159], v7, s[24:27], s67 offen offset:1024 sc1
  v_mfma_f32_16x16x32_bf16 v[204:207], v[24:27], a[164:167], v[204:207]
  v_mfma_f32_16x16x32_bf16 v[208:211], v[24:27], a[168:171], v[208:211]
  v_mfma_f32_16x16x32_bf16 v[212:215], v[24:27], a[172:175], v[212:215]
  s_waitcnt vmcnt(12)
  v_mfma_f32_16x16x32_bf16 v[200:203], v[28:31], a[176:179], v[200:203]
  buffer_load_dwordx4 v[160:163], v7, s[24:27], s68 offen offset:0 sc1
  v_mfma_f32_16x16x32_bf16 v[204:207], v[28:31], a[180:183], v[204:207]
  v_mfma_f32_16x16x32_bf16 v[208:211], v[28:31], a[184:187], v[208:211]
  v_mfma_f32_16x16x32_bf16 v[212:215], v[28:31], a[188:191], v[212:215]
  s_waitcnt vmcnt(12)
  v_mfma_f32_16x16x32_bf16 v[200:203], v[128:131], a[192:195], v[200:203]
  buffer_load_dwordx4 v[164:167], v7, s[24:27], s68 offen offset:1024 sc1
  v_mfma_f32_16x16x32_bf16 v[204:207], v[128:131], a[196:199], v[204:207]
  v_mfma_f32_16x16x32_bf16 v[208:211], v[128:131], a[200:203], v[208:211]
  v_mfma_f32_16x16x32_bf16 v[212:215], v[128:131], a[204:207], v[212:215]
  s_waitcnt vmcnt(12)
  v_mfma_f32_16x16x32_bf16 v[200:203], v[132:135], a[208:211], v[200:203]
  buffer_load_dwordx4 v[168:171], v7, s[24:27], s69 offen offset:0 sc1
  v_mfma_f32_16x16x32_bf16 v[204:207], v[132:135], a[212:215], v[204:207]
  v_mfma_f32_16x16x32_bf16 v[208:211], v[132:135], a[216:219], v[208:211]
  v_mfma_f32_16x16x32_bf16 v[212:215], v[132:135], a[220:223], v[212:215]
  s_waitcnt vmcnt(12)
  v_mfma_f32_16x16x32_bf16 v[200:203], v[136:139], a[224:227], v[200:203]
  buffer_load_dwordx4 v[172:175], v7, s[24:27], s69 offen offset:1024 sc1
  v_mfma_f32_16x16x32_bf16 v[204:207], v[136:139], a[228:231], v[204:207]
  v_mfma_f32_16x16x32_bf16 v[208:211], v[136:139], a[232:235], v[208:211]
  v_mfma_f32_16x16x32_bf16 v[212:215], v[136:139], a[236:239], v[212:215]
  s_waitcnt vmcnt(12)
  v_mfma_f32_16x16x32_bf16 v[200:203], v[140:143], a[240:243], v[200:203]
  buffer_load_dwordx4 v[16:19], v7, s[24:27], s70 offen offset:0 sc1
  v_mfma_f32_16x16x32_bf16 v[204:207], v[140:143], a[244:247], v[204:207]
  v_mfma_f32_16x16x32_bf16 v[208:211], v[140:143], a[248:251], v[208:211]
  v_mfma_f32_16x16x32_bf16 v[212:215], v[140:143], a[252:255], v[212:215]
  s_waitcnt vmcnt(12)
  v_mfma_f32_16x16x32_bf16 v[216:219], v[48:51], a[0:3], v[36:39]
  buffer_load_dwordx4 v[20:23], v7, s[24:27], s70 offen offset:1024 sc1
  v_mfma_f32_16x16x32_bf16 v[220:223], v[48:51], a[4:7], 0
  v_mfma_f32_16x16x32_bf16 v[224:227], v[48:51], a[8:11], 0
  v_mfma_f32_16x16x32_bf16 v[228:231], v[48:51], a[12:15], 0
  s_waitcnt vmcnt(12)
  v_mfma_f32_16x16x32_bf16 v[216:219], v[52:55], a[16:19], v[216:219]
  buffer_load_dwordx4 v[24:27], v7, s[24:27], s71 offen offset:0 sc1
  v_mfma_f32_16x16x32_bf16 v[220:223], v[52:55], a[20:23], v[220:223]
  ds_write_b128 v9, v[204:207] offset:0
  v_mfma_f32_16x16x32_bf16 v[224:227], v[52:55], a[24:27], v[224:227]
  ds_write_b128 v10, v[208:211] offset:0
  v_mfma_f32_16x16x32_bf16 v[228:231], v[52:55], a[28:31], v[228:231]
  ds_write_b128 v11, v[212:215] offset:0
  s_waitcnt vmcnt(12)
  v_mfma_f32_16x16x32_bf16 v[216:219], v[56:59], a[32:35], v[216:219]
  buffer_load_dwordx4 v[28:31], v7, s[24:27], s71 offen offset:1024 sc1
  v_add_u32 v7, 65536, v7
  v_mfma_f32_16x16x32_bf16 v[220:223], v[56:59], a[36:39], v[220:223]
  v_mfma_f32_16x16x32_bf16 v[224:227], v[56:59], a[40:43], v[224:227]
  v_mfma_f32_16x16x32_bf16 v[228:231], v[56:59], a[44:47], v[228:231]
  s_waitcnt vmcnt(12)
  v_mfma_f32_16x16x32_bf16 v[216:219], v[60:63], a[48:51], v[216:219]
  buffer_load_dwordx4 v[128:131], v7, s[24:27], s64 offen offset:0 sc1
  v_mfma_f32_16x16x32_bf16 v[220:223], v[60:63], a[52:55], v[220:223]
  v_mfma_f32_16x16x32_bf16 v[224:227], v[60:63], a[56:59], v[224:227]
  v_mfma_f32_16x16x32_bf16 v[228:231], v[60:63], a[60:63], v[228:231]
  s_waitcnt lgkmcnt(0)
  s_barrier
  s_waitcnt vmcnt(12)
  v_mfma_f32_16x16x32_bf16 v[216:219], v[144:147], a[64:67], v[216:219]
  buffer_load_dwordx4 v[132:135], v7, s[24:27], s64 offen offset:1024 sc1
  v_mfma_f32_16x16x32_bf16 v[220:223], v[144:147], a[68:71], v[220:223]
  ds_read_b128 v[232:235], v13 offset:0
  v_mfma_f32_16x16x32_bf16 v[224:227], v[144:147], a[72:75], v[224:227]
  ds_read_b128 v[236:239], v13 offset:1024
  v_mfma_f32_16x16x32_bf16 v[228:231], v[144:147], a[76:79], v[228:231]
  ds_read_b128 v[240:243], v13 offset:2048
  s_waitcnt vmcnt(12)
  v_mfma_f32_16x16x32_bf16 v[216:219], v[148:151], a[80:83], v[216:219]
  buffer_load_dwordx4 v[136:139], v7, s[24:27], s65 offen offset:0 sc1
  v_mfma_f32_16x16x32_bf16 v[220:223], v[148:151], a[84:87], v[220:223]
  v_mfma_f32_16x16x32_bf16 v[224:227], v[148:151], a[88:91], v[224:227]
  v_mfma_f32_16x16x32_bf16 v[228:231], v[148:151], a[92:95], v[228:231]
  s_waitcnt vmcnt(12)
  v_mfma_f32_16x16x32_bf16 v[216:219], v[152:155], a[96:99], v[216:219]
  buffer_load_dwordx4 v[140:143], v7, s[24:27], s65 offen offset:1024 sc1
  v_mfma_f32_16x16x32_bf16 v[220:223], v[152:155], a[100:103], v[220:223]
  v_mfma_f32_16x16x32_bf16 v[224:227], v[152:155], a[104:107], v[224:227]
  s_waitcnt lgkmcnt(0)
  v_mfma_f32_16x16x32_bf16 v[228:231], v[152:155], a[108:111], v[228:231]
  v_add_f32 v232, v232, v236
  v_add_f32 v240, v240, v200
  s_waitcnt vmcnt(12)
  v_mfma_f32_16x16x32_bf16 v[216:219], v[156:159], a[112:115], v[216:219]
  buffer_load_dwordx4 v[48:51], v7, s[24:27], s66 offen offset:0 sc1
  v_mfma_f32_16x16x32_bf16 v[220:223], v[156:159], a[116:119], v[220:223]
  v_add_f32 v233, v233, v237
  v_add_f32 v241, v241, v201
  v_mfma_f32_16x16x32_bf16 v[224:227], v[156:159], a[120:123], v[224:227]
  v_add_f32 v234, v234, v238
  v_add_f32 v242, v242, v202
  v_mfma_f32_16x16x32_bf16 v[228:231], v[156:159], a[124:127], v[228:231]
  v_add_f32 v235, v235, v239
  v_add_f32 v243, v243, v203
  s_waitcnt vmcnt(12)
  v_mfma_f32_16x16x32_bf16 v[216:219], v[160:163], a[128:131], v[216:219]
  buffer_load_dwordx4 v[52:55], v7, s[24:27], s66 offen offset:1024 sc1
  v_mfma_f32_16x16x32_bf16 v[220:223], v[160:163], a[132:135], v[220:223]
  v_add_f32 v232, v232, v240
  v_add_f32 v233, v233, v241
  v_mfma_f32_16x16x32_bf16 v[224:227], v[160:163], a[136:139], v[224:227]
  v_add_f32 v234, v234, v242
  v_add_f32 v235, v235, v243
  v_mfma_f32_16x16x32_bf16 v[228:231], v[160:163], a[140:143], v[228:231]
  v_mul_f32 v232, v232, v176
  v_mul_f32 v233, v233, v177
  s_waitcnt vmcnt(12)
  v_mfma_f32_16x16x32_bf16 v[216:219], v[164:167], a[144:147], v[216:219]
  buffer_load_dwordx4 v[56:59], v7, s[24:27], s67 offen offset:0 sc1
  v_mfma_f32_16x16x32_bf16 v[220:223], v[164:167], a[148:151], v[220:223]
  v_mul_f32 v234, v234, v178
  v_mul_f32 v235, v235, v179
  v_mfma_f32_16x16x32_bf16 v[224:227], v[164:167], a[152:155], v[224:227]
  v_cvt_pk_bf16_f32 v244, v232, v233
  v_cvt_pk_bf16_f32 v245, v234, v235
  v_mfma_f32_16x16x32_bf16 v[228:231], v[164:167], a[156:159], v[228:231]
  s_waitcnt vmcnt(12)
  v_mfma_f32_16x16x32_bf16 v[216:219], v[168:171], a[160:163], v[216:219]
  buffer_load_dwordx4 v[60:63], v7, s[24:27], s67 offen offset:1024 sc1
  v_mfma_f32_16x16x32_bf16 v[220:223], v[168:171], a[164:167], v[220:223]
  v_mfma_f32_16x16x32_bf16 v[224:227], v[168:171], a[168:171], v[224:227]
  v_mfma_f32_16x16x32_bf16 v[228:231], v[168:171], a[172:175], v[228:231]
  s_waitcnt vmcnt(12)
  v_mfma_f32_16x16x32_bf16 v[216:219], v[172:175], a[176:179], v[216:219]
  buffer_load_dwordx4 v[144:147], v7, s[24:27], s68 offen offset:0 sc1
  v_mfma_f32_16x16x32_bf16 v[220:223], v[172:175], a[180:183], v[220:223]
  v_mfma_f32_16x16x32_bf16 v[224:227], v[172:175], a[184:187], v[224:227]
  v_mfma_f32_16x16x32_bf16 v[228:231], v[172:175], a[188:191], v[228:231]
  s_waitcnt vmcnt(12)
  v_mfma_f32_16x16x32_bf16 v[216:219], v[16:19], a[192:195], v[216:219]
  buffer_load_dwordx4 v[148:151], v7, s[24:27], s68 offen offset:1024 sc1
  v_mfma_f32_16x16x32_bf16 v[220:223], v[16:19], a[196:199], v[220:223]
  v_mfma_f32_16x16x32_bf16 v[224:227], v[16:19], a[200:203], v[224:227]
  v_mfma_f32_16x16x32_bf16 v[228:231], v[16:19], a[204:207], v[228:231]
  s_waitcnt vmcnt(12)
  v_mfma_f32_16x16x32_bf16 v[216:219], v[20:23], a[208:211], v[216:219]
  buffer_load_dwordx4 v[152:155], v7, s[24:27], s69 offen offset:0 sc1
  v_mfma_f32_16x16x32_bf16 v[220:223], v[20:23], a[212:215], v[220:223]
  v_mfma_f32_16x16x32_bf16 v[224:227], v[20:23], a[216:219], v[224:227]
  v_mfma_f32_16x16x32_bf16 v[228:231], v[20:23], a[220:223], v[228:231]
  s_waitcnt vmcnt(12)
  v_mfma_f32_16x16x32_bf16 v[216:219], v[24:27], a[224:227], v[216:219]
  buffer_load_dwordx4 v[156:159], v7, s[24:27], s69 offen offset:1024 sc1
  v_mfma_f32_16x16x32_bf16 v[220:223], v[24:27], a[228:231], v[220:223]
  v_mfma_f32_16x16x32_bf16 v[224:227], v[24:27], a[232:235], v[224:227]
  v_mfma_f32_16x16x32_bf16 v[228:231], v[24:27], a[236:239], v[228:231]
  s_waitcnt vmcnt(12)
  v_mfma_f32_16x16x32_bf16 v[216:219], v[28:31], a[240:243], v[216:219]
  buffer_load_dwordx4 v[160:163], v7, s[24:27], s70 offen offset:0 sc1
  v_mfma_f32_16x16x32_bf16 v[220:223], v[28:31], a[244:247], v[220:223]
  v_mfma_f32_16x16x32_bf16 v[224:227], v[28:31], a[248:251], v[224:227]
  v_mfma_f32_16x16x32_bf16 v[228:231], v[28:31], a[252:255], v[228:231]
  s_waitcnt vmcnt(12)
  v_mfma_f32_16x16x32_bf16 v[200:203], v[128:131], a[0:3], v[36:39]
  buffer_load_dwordx4 v[164:167], v7, s[24:27], s70 offen offset:1024 sc1
  v_mfma_f32_16x16x32_bf16 v[204:207], v[128:131], a[4:7], 0
  v_mfma_f32_16x16x32_bf16 v[208:211], v[128:131], a[8:11], 0
  v_mfma_f32_16x16x32_bf16 v[212:215], v[128:131], a[12:15], 0
  s_waitcnt vmcnt(12)
  v_mfma_f32_16x16x32_bf16 v[200:203], v[132:135], a[16:19], v[200:203]
  buffer_load_dwordx4 v[168:171], v7, s[24:27], s71 offen offset:0 sc1
  v_mfma_f32_16x16x32_bf16 v[204:207], v[132:135], a[20:23], v[204:207]
  ds_write_b128 v9, v[220:223] offset:16384
  v_mfma_f32_16x16x32_bf16 v[208:211], v[132:135], a[24:27], v[208:211]
  ds_write_b128 v10, v[224:227] offset:16384
  v_mfma_f32_16x16x32_bf16 v[212:215], v[132:135], a[28:31], v[212:215]
  ds_write_b128 v11, v[228:231] offset:16384
  s_waitcnt vmcnt(12)
  v_mfma_f32_16x16x32_bf16 v[200:203], v[136:139], a[32:35], v[200:203]
  buffer_load_dwordx4 v[172:175], v7, s[24:27], s71 offen offset:1024 sc1
  v_add_u32 v7, 65536, v7
  v_mfma_f32_16x16x32_bf16 v[204:207], v[136:139], a[36:39], v[204:207]
  v_mfma_f32_16x16x32_bf16 v[208:211], v[136:139], a[40:43], v[208:211]
  v_mfma_f32_16x16x32_bf16 v[212:215], v[136:139], a[44:47], v[212:215]
  s_waitcnt vmcnt(12)
  v_mfma_f32_16x16x32_bf16 v[200:203], v[140:143], a[48:51], v[200:203]
  buffer_load_dwordx4 v[16:19], v7, s[24:27], s64 offen offset:0 sc1
  v_mfma_f32_16x16x32_bf16 v[204:207], v[140:143], a[52:55], v[204:207]
  v_mfma_f32_16x16x32_bf16 v[208:211], v[140:143], a[56:59], v[208:211]
  v_mfma_f32_16x16x32_bf16 v[212:215], v[140:143], a[60:63], v[212:215]
  s_waitcnt lgkmcnt(0)
  s_barrier
  s_waitcnt vmcnt(12)
  v_mfma_f32_16x16x32_bf16 v[200:203], v[48:51], a[64:67], v[200:203]
  buffer_load_dwordx4 v[20:23], v7, s[24:27], s64 offen offset:1024 sc1
  v_mfma_f32_16x16x32_bf16 v[204:207], v[48:51], a[68:71], v[204:207]
  ds_read_b128 v[232:235], v13 offset:16384
  v_mfma_f32_16x16x32_bf16 v[208:211], v[48:51], a[72:75], v[208:211]
  ds_read_b128 v[236:239], v13 offset:17408
  v_mfma_f32_16x16x32_bf16 v[212:215], v[48:51], a[76:79], v[212:215]
  ds_read_b128 v[240:243], v13 offset:18432
  s_waitcnt vmcnt(12)
  v_mfma_f32_16x16x32_bf16 v[200:203], v[52:55], a[80:83], v[200:203]
  buffer_load_dwordx4 v[24:27], v7, s[24:27], s65 offen offset:0 sc1
  v_mfma_f32_16x16x32_bf16 v[204:207], v[52:55], a[84:87], v[204:207]
  v_mfma_f32_16x16x32_bf16 v[208:211], v[52:55], a[88:91], v[208:211]
  v_mfma_f32_16x16x32_bf16 v[212:215], v[52:55], a[92:95], v[212:215]
  s_waitcnt vmcnt(12)
  v_mfma_f32_16x16x32_bf16 v[200:203], v[56:59], a[96:99], v[200:203]
  buffer_load_dwordx4 v[28:31], v7, s[24:27], s65 offen offset:1024 sc1
  v_mfma_f32_16x16x32_bf16 v[204:207], v[56:59], a[100:103], v[204:207]
  v_mfma_f32_16x16x32_bf16 v[208:211], v[56:59], a[104:107], v[208:211]
  s_waitcnt lgkmcnt(0)
  v_mfma_f32_16x16x32_bf16 v[212:215], v[56:59], a[108:111], v[212:215]
  v_add_f32 v232, v232, v236
  v_add_f32 v240, v240, v216
  s_waitcnt vmcnt(12)
  v_mfma_f32_16x16x32_bf16 v[200:203], v[60:63], a[112:115], v[200:203]
  buffer_load_dwordx4 v[128:131], v7, s[24:27], s66 offen offset:0 sc1
  v_mfma_f32_16x16x32_bf16 v[204:207], v[60:63], a[116:119], v[204:207]
  v_add_f32 v233, v233, v237
  v_add_f32 v241, v241, v217
  v_mfma_f32_16x16x32_bf16 v[208:211], v[60:63], a[120:123], v[208:211]
  v_add_f32 v234, v234, v238
  v_add_f32 v242, v242, v218
  v_mfma_f32_16x16x32_bf16 v[212:215], v[60:63], a[124:127], v[212:215]
  v_add_f32 v235, v235, v239
  v_add_f32 v243, v243, v219
  s_waitcnt vmcnt(12)
  v_mfma_f32_16x16x32_bf16 v[200:203], v[144:147], a[128:131], v[200:203]
  buffer_load_dwordx4 v[132:135], v7, s[24:27], s66 offen offset:1024 sc1
  v_mfma_f32_16x16x32_bf16 v[204:207], v[144:147], a[132:135], v[204:207]
  v_add_f32 v232, v232, v240
  v_add_f32 v233, v233, v241
  v_mfma_f32_16x16x32_bf16 v[208:211], v[144:147], a[136:139], v[208:211]
  v_add_f32 v234, v234, v242
  v_add_f32 v235, v235, v243
  v_mfma_f32_16x16x32_bf16 v[212:215], v[144:147], a[140:143], v[212:215]
  v_mul_f32 v232, v232, v180
  v_mul_f32 v233, v233, v181
  s_waitcnt vmcnt(12)
  v_mfma_f32_16x16x32_bf16 v[200:203], v[148:151], a[144:147], v[200:203]
  buffer_load_dwordx4 v[136:139], v7, s[24:27], s67 offen offset:0 sc1
  v_mfma_f32_16x16x32_bf16 v[204:207], v[148:151], a[148:151], v[204:207]
  v_mul_f32 v234, v234, v182
  v_mul_f32 v235, v235, v183
  v_mfma_f32_16x16x32_bf16 v[208:211], v[148:151], a[152:155], v[208:211]
  v_cvt_pk_bf16_f32 v246, v232, v233
  v_cvt_pk_bf16_f32 v247, v234, v235
  v_mfma_f32_16x16x32_bf16 v[212:215], v[148:151], a[156:159], v[212:215]
  s_waitcnt vmcnt(12)
  v_mfma_f32_16x16x32_bf16 v[200:203], v[152:155], a[160:163], v[200:203]
  buffer_load_dwordx4 v[140:143], v7, s[24:27], s67 offen offset:1024 sc1
  v_mfma_f32_16x16x32_bf16 v[204:207], v[152:155], a[164:167], v[204:207]
  v_mfma_f32_16x16x32_bf16 v[208:211], v[152:155], a[168:171], v[208:211]
  v_mfma_f32_16x16x32_bf16 v[212:215], v[152:155], a[172:175], v[212:215]
  s_waitcnt vmcnt(12)
  v_mfma_f32_16x16x32_bf16 v[200:203], v[156:159], a[176:179], v[200:203]
  buffer_load_dwordx4 v[48:51], v7, s[24:27], s68 offen offset:0 sc1
  v_mfma_f32_16x16x32_bf16 v[204:207], v[156:159], a[180:183], v[204:207]
  v_mfma_f32_16x16x32_bf16 v[208:211], v[156:159], a[184:187], v[208:211]
  v_mfma_f32_16x16x32_bf16 v[212:215], v[156:159], a[188:191], v[212:215]
  s_waitcnt vmcnt(12)
  v_mfma_f32_16x16x32_bf16 v[200:203], v[160:163], a[192:195], v[200:203]
  buffer_load_dwordx4 v[52:55], v7, s[24:27], s68 offen offset:1024 sc1
  v_mfma_f32_16x16x32_bf16 v[204:207], v[160:163], a[196:199], v[204:207]
  v_mfma_f32_16x16x32_bf16 v[208:211], v[160:163], a[200:203], v[208:211]
  v_mfma_f32_16x16x32_bf16 v[212:215], v[160:163], a[204:207], v[212:215]
  s_waitcnt vmcnt(12)
  v_mfma_f32_16x16x32_bf16 v[200:203], v[164:167], a[208:211], v[200:203]
  buffer_load_dwordx4 v[56:59], v7, s[24:27], s69 offen offset:0 sc1
  v_mfma_f32_16x16x32_bf16 v[204:207], v[164:167], a[212:215], v[204:207]
  v_mfma_f32_16x16x32_bf16 v[208:211], v[164:167], a[216:219], v[208:211]
  v_mfma_f32_16x16x32_bf16 v[212:215], v[164:167], a[220:223], v[212:215]
  s_waitcnt vmcnt(12)
  v_mfma_f32_16x16x32_bf16 v[200:203], v[168:171], a[224:227], v[200:203]
  buffer_load_dwordx4 v[60:63], v7, s[24:27], s69 offen offset:1024 sc1
  v_mfma_f32_16x16x32_bf16 v[204:207], v[168:171], a[228:231], v[204:207]
  v_mfma_f32_16x16x32_bf16 v[208:211], v[168:171], a[232:235], v[208:211]
  v_mfma_f32_16x16x32_bf16 v[212:215], v[168:171], a[236:239], v[212:215]
  s_waitcnt vmcnt(12)
  v_mfma_f32_16x16x32_bf16 v[200:203], v[172:175], a[240:243], v[200:203]
  buffer_load_dwordx4 v[144:147], v7, s[24:27], s70 offen offset:0 sc1
  v_mfma_f32_16x16x32_bf16 v[204:207], v[172:175], a[244:247], v[204:207]
  v_mfma_f32_16x16x32_bf16 v[208:211], v[172:175], a[248:251], v[208:211]
  v_mfma_f32_16x16x32_bf16 v[212:215], v[172:175], a[252:255], v[212:215]
  s_waitcnt vmcnt(12)
  v_mfma_f32_16x16x32_bf16 v[216:219], v[16:19], a[0:3], v[36:39]
  buffer_load_dwordx4 v[148:151], v7, s[24:27], s70 offen offset:1024 sc1
  v_mfma_f32_16x16x32_bf16 v[220:223], v[16:19], a[4:7], 0
  v_mfma_f32_16x16x32_bf16 v[224:227], v[16:19], a[8:11], 0
  v_mfma_f32_16x16x32_bf16 v[228:231], v[16:19], a[12:15], 0
  s_waitcnt vmcnt(12)
  v_mfma_f32_16x16x32_bf16 v[216:219], v[20:23], a[16:19], v[216:219]
  buffer_load_dwordx4 v[152:155], v7, s[24:27], s71 offen offset:0 sc1
  v_mfma_f32_16x16x32_bf16 v[220:223], v[20:23], a[20:23], v[220:223]
  ds_write_b128 v9, v[204:207] offset:0
  v_mfma_f32_16x16x32_bf16 v[224:227], v[20:23], a[24:27], v[224:227]
  ds_write_b128 v10, v[208:211] offset:0
  v_mfma_f32_16x16x32_bf16 v[228:231], v[20:23], a[28:31], v[228:231]
  ds_write_b128 v11, v[212:215] offset:0
  s_waitcnt vmcnt(12)
  v_mfma_f32_16x16x32_bf16 v[216:219], v[24:27], a[32:35], v[216:219]
  buffer_load_dwordx4 v[156:159], v7, s[24:27], s71 offen offset:1024 sc1
  v_add_u32 v7, 65536, v7
  v_mfma_f32_16x16x32_bf16 v[220:223], v[24:27], a[36:39], v[220:223]
  v_mfma_f32_16x16x32_bf16 v[224:227], v[24:27], a[40:43], v[224:227]
  v_mfma_f32_16x16x32_bf16 v[228:231], v[24:27], a[44:47], v[228:231]
  s_waitcnt vmcnt(12)
  v_mfma_f32_16x16x32_bf16 v[216:219], v[28:31], a[48:51], v[216:219]
  buffer_load_dwordx4 v[160:163], v7, s[24:27], s64 offen offset:0 sc1
  v_mfma_f32_16x16x32_bf16 v[220:223], v[28:31], a[52:55], v[220:223]
  v_mfma_f32_16x16x32_bf16 v[224:227], v[28:31], a[56:59], v[224:227]
  v_mfma_f32_16x16x32_bf16 v[228:231], v[28:31], a[60:63], v[228:231]
  s_waitcnt lgkmcnt(0)
  s_barrier
  s_waitcnt vmcnt(12)
  v_mfma_f32_16x16x32_bf16 v[216:219], v[128:131], a[64:67], v[216:219]
  buffer_load_dwordx4 v[164:167], v7, s[24:27], s64 offen offset:1024 sc1
  v_mfma_f32_16x16x32_bf16 v[220:223], v[128:131], a[68:71], v[220:223]
  ds_read_b128 v[232:235], v13 offset:0
  v_mfma_f32_16x16x32_bf16 v[224:227], v[128:131], a[72:75], v[224:227]
  ds_read_b128 v[236:239], v13 offset:1024
  v_mfma_f32_16x16x32_bf16 v[228:231], v[128:131], a[76:79], v[228:231]
  ds_read_b128 v[240:243], v13 offset:2048
  s_waitcnt vmcnt(12)
  v_mfma_f32_16x16x32_bf16 v[216:219], v[132:135], a[80:83], v[216:219]
  buffer_load_dwordx4 v[168:171], v7, s[24:27], s65 offen offset:0 sc1
  v_mfma_f32_16x16x32_bf16 v[220:223], v[132:135], a[84:87], v[220:223]
  v_mfma_f32_16x16x32_bf16 v[224:227], v[132:135], a[88:91], v[224:227]
  v_mfma_f32_16x16x32_bf16 v[228:231], v[132:135], a[92:95], v[228:231]
  s_waitcnt vmcnt(12)
  v_mfma_f32_16x16x32_bf16 v[216:219], v[136:139], a[96:99], v[216:219]
  buffer_load_dwordx4 v[172:175], v7, s[24:27], s65 offen offset:1024 sc1
  v_mfma_f32_16x16x32_bf16 v[220:223], v[136:139], a[100:103], v[220:223]
  v_mfma_f32_16x16x32_bf16 v[224:227], v[136:139], a[104:107], v[224:227]
  s_waitcnt lgkmcnt(0)
  v_mfma_f32_16x16x32_bf16 v[228:231], v[136:139], a[108:111], v[228:231]
  v_add_f32 v232, v232, v236
  v_add_f32 v240, v240, v200
  s_waitcnt vmcnt(12)
  v_mfma_f32_16x16x32_bf16 v[216:219], v[140:143], a[112:115], v[216:219]
  buffer_load_dwordx4 v[16:19], v7, s[24:27], s66 offen offset:0 sc1
  v_mfma_f32_16x16x32_bf16 v[220:223], v[140:143], a[116:119], v[220:223]
  v_add_f32 v233, v233, v237
  v_add_f32 v241, v241, v201
  v_mfma_f32_16x16x32_bf16 v[224:227], v[140:143], a[120:123], v[224:227]
  v_add_f32 v234, v234, v238
  v_add_f32 v242, v242, v202
  v_mfma_f32_16x16x32_bf16 v[228:231], v[140:143], a[124:127], v[228:231]
  v_add_f32 v235, v235, v239
  v_add_f32 v243, v243, v203
  s_waitcnt vmcnt(12)
  v_mfma_f32_16x16x32_bf16 v[216:219], v[48:51], a[128:131], v[216:219]
  buffer_load_dwordx4 v[20:23], v7, s[24:27], s66 offen offset:1024 sc1
  v_mfma_f32_16x16x32_bf16 v[220:223], v[48:51], a[132:135], v[220:223]
  v_add_f32 v232, v232, v240
  v_add_f32 v233, v233, v241
  v_mfma_f32_16x16x32_bf16 v[224:227], v[48:51], a[136:139], v[224:227]
  v_add_f32 v234, v234, v242
  v_add_f32 v235, v235, v243
  v_mfma_f32_16x16x32_bf16 v[228:231], v[48:51], a[140:143], v[228:231]
  v_mul_f32 v232, v232, v184
  v_mul_f32 v233, v233, v185
  s_waitcnt vmcnt(12)
  v_mfma_f32_16x16x32_bf16 v[216:219], v[52:55], a[144:147], v[216:219]
  buffer_load_dwordx4 v[24:27], v7, s[24:27], s67 offen offset:0 sc1
  v_mfma_f32_16x16x32_bf16 v[220:223], v[52:55], a[148:151], v[220:223]
  v_mul_f32 v234, v234, v186
  v_mul_f32 v235, v235, v187
  v_mfma_f32_16x16x32_bf16 v[224:227], v[52:55], a[152:155], v[224:227]
  v_cvt_pk_bf16_f32 v248, v232, v233
  v_cvt_pk_bf16_f32 v249, v234, v235
  v_mfma_f32_16x16x32_bf16 v[228:231], v[52:55], a[156:159], v[228:231]
  s_waitcnt vmcnt(12)
  v_mfma_f32_16x16x32_bf16 v[216:219], v[56:59], a[160:163], v[216:219]
  buffer_load_dwordx4 v[28:31], v7, s[24:27], s67 offen offset:1024 sc1
  v_mfma_f32_16x16x32_bf16 v[220:223], v[56:59], a[164:167], v[220:223]
  v_mfma_f32_16x16x32_bf16 v[224:227], v[56:59], a[168:171], v[224:227]
  v_mfma_f32_16x16x32_bf16 v[228:231], v[56:59], a[172:175], v[228:231]
  s_waitcnt vmcnt(12)
  v_mfma_f32_16x16x32_bf16 v[216:219], v[60:63], a[176:179], v[216:219]
  buffer_load_dwordx4 v[128:131], v7, s[24:27], s68 offen offset:0 sc1
  v_mfma_f32_16x16x32_bf16 v[220:223], v[60:63], a[180:183], v[220:223]
  v_mfma_f32_16x16x32_bf16 v[224:227], v[60:63], a[184:187], v[224:227]
  v_mfma_f32_16x16x32_bf16 v[228:231], v[60:63], a[188:191], v[228:231]
  s_waitcnt vmcnt(12)
  v_mfma_f32_16x16x32_bf16 v[216:219], v[144:147], a[192:195], v[216:219]
  buffer_load_dwordx4 v[132:135], v7, s[24:27], s68 offen offset:1024 sc1
  v_mfma_f32_16x16x32_bf16 v[220:223], v[144:147], a[196:199], v[220:223]
  v_mfma_f32_16x16x32_bf16 v[224:227], v[144:147], a[200:203], v[224:227]
  v_mfma_f32_16x16x32_bf16 v[228:231], v[144:147], a[204:207], v[228:231]
  s_waitcnt vmcnt(12)
  v_mfma_f32_16x16x32_bf16 v[216:219], v[148:151], a[208:211], v[216:219]
  buffer_load_dwordx4 v[136:139], v7, s[24:27], s69 offen offset:0 sc1
  v_mfma_f32_16x16x32_bf16 v[220:223], v[148:151], a[212:215], v[220:223]
  v_mfma_f32_16x16x32_bf16 v[224:227], v[148:151], a[216:219], v[224:227]
  v_mfma_f32_16x16x32_bf16 v[228:231], v[148:151], a[220:223], v[228:231]
  s_waitcnt vmcnt(12)
  v_mfma_f32_16x16x32_bf16 v[216:219], v[152:155], a[224:227], v[216:219]
  buffer_load_dwordx4 v[140:143], v7, s[24:27], s69 offen offset:1024 sc1
  v_mfma_f32_16x16x32_bf16 v[220:223], v[152:155], a[228:231], v[220:223]
  v_mfma_f32_16x16x32_bf16 v[224:227], v[152:155], a[232:235], v[224:227]
  v_mfma_f32_16x16x32_bf16 v[228:231], v[152:155], a[236:239], v[228:231]
  s_waitcnt vmcnt(12)
  v_mfma_f32_16x16x32_bf16 v[216:219], v[156:159], a[240:243], v[216:219]
  buffer_load_dwordx4 v[48:51], v7, s[24:27], s70 offen offset:0 sc1
  v_mfma_f32_16x16x32_bf16 v[220:223], v[156:159], a[244:247], v[220:223]
  v_mfma_f32_16x16x32_bf16 v[224:227], v[156:159], a[248:251], v[224:227]
  v_mfma_f32_16x16x32_bf16 v[228:231], v[156:159], a[252:255], v[228:231]
  s_waitcnt vmcnt(12)
  v_mfma_f32_16x16x32_bf16 v[200:203], v[160:163], a[0:3], v[36:39]
  buffer_load_dwordx4 v[52:55], v7, s[24:27], s70 offen offset:1024 sc1
  v_mfma_f32_16x16x32_bf16 v[204:207], v[160:163], a[4:7], 0
  v_mfma_f32_16x16x32_bf16 v[208:211], v[160:163], a[8:11], 0
  v_mfma_f32_16x16x32_bf16 v[212:215], v[160:163], a[12:15], 0
  s_waitcnt vmcnt(12)
  v_mfma_f32_16x16x32_bf16 v[200:203], v[164:167], a[16:19], v[200:203]
  buffer_load_dwordx4 v[56:59], v7, s[24:27], s71 offen offset:0 sc1
  v_mfma_f32_16x16x32_bf16 v[204:207], v[164:167], a[20:23], v[204:207]
  ds_write_b128 v9, v[220:223] offset:16384
  v_mfma_f32_16x16x32_bf16 v[208:211], v[164:167], a[24:27], v[208:211]
  ds_write_b128 v10, v[224:227] offset:16384
  v_mfma_f32_16x16x32_bf16 v[212:215], v[164:167], a[28:31], v[212:215]
  ds_write_b128 v11, v[228:231] offset:16384
  s_waitcnt vmcnt(12)
  v_mfma_f32_16x16x32_bf16 v[200:203], v[168:171], a[32:35], v[200:203]
  buffer_load_dwordx4 v[60:63], v7, s[24:27], s71 offen offset:1024 sc1
  v_add_u32 v7, 65536, v7
  v_mfma_f32_16x16x32_bf16 v[204:207], v[168:171], a[36:39], v[204:207]
  v_mfma_f32_16x16x32_bf16 v[208:211], v[168:171], a[40:43], v[208:211]
  v_mfma_f32_16x16x32_bf16 v[212:215], v[168:171], a[44:47], v[212:215]
  s_waitcnt vmcnt(12)
  v_mfma_f32_16x16x32_bf16 v[200:203], v[172:175], a[48:51], v[200:203]
  buffer_load_dwordx4 v[144:147], v7, s[24:27], s64 offen offset:0 sc1
  v_mfma_f32_16x16x32_bf16 v[204:207], v[172:175], a[52:55], v[204:207]
  v_mfma_f32_16x16x32_bf16 v[208:211], v[172:175], a[56:59], v[208:211]
  v_mfma_f32_16x16x32_bf16 v[212:215], v[172:175], a[60:63], v[212:215]
  s_waitcnt lgkmcnt(0)
  s_barrier
  s_waitcnt vmcnt(12)
  v_mfma_f32_16x16x32_bf16 v[200:203], v[16:19], a[64:67], v[200:203]
  buffer_load_dwordx4 v[148:151], v7, s[24:27], s64 offen offset:1024 sc1
  v_mfma_f32_16x16x32_bf16 v[204:207], v[16:19], a[68:71], v[204:207]
  ds_read_b128 v[232:235], v13 offset:16384
  v_mfma_f32_16x16x32_bf16 v[208:211], v[16:19], a[72:75], v[208:211]
  ds_read_b128 v[236:239], v13 offset:17408
  v_mfma_f32_16x16x32_bf16 v[212:215], v[16:19], a[76:79], v[212:215]
  ds_read_b128 v[240:243], v13 offset:18432
  s_waitcnt vmcnt(12)
  v_mfma_f32_16x16x32_bf16 v[200:203], v[20:23], a[80:83], v[200:203]
  buffer_load_dwordx4 v[152:155], v7, s[24:27], s65 offen offset:0 sc1
  v_mfma_f32_16x16x32_bf16 v[204:207], v[20:23], a[84:87], v[204:207]
  v_mfma_f32_16x16x32_bf16 v[208:211], v[20:23], a[88:91], v[208:211]
  v_mfma_f32_16x16x32_bf16 v[212:215], v[20:23], a[92:95], v[212:215]
  s_waitcnt vmcnt(12)
  v_mfma_f32_16x16x32_bf16 v[200:203], v[24:27], a[96:99], v[200:203]
  buffer_load_dwordx4 v[156:159], v7, s[24:27], s65 offen offset:1024 sc1
  v_mfma_f32_16x16x32_bf16 v[204:207], v[24:27], a[100:103], v[204:207]
  v_mfma_f32_16x16x32_bf16 v[208:211], v[24:27], a[104:107], v[208:211]
  s_waitcnt lgkmcnt(0)
  v_mfma_f32_16x16x32_bf16 v[212:215], v[24:27], a[108:111], v[212:215]
  v_add_f32 v232, v232, v236
  v_add_f32 v240, v240, v216
  s_waitcnt vmcnt(12)
  v_mfma_f32_16x16x32_bf16 v[200:203], v[28:31], a[112:115], v[200:203]
  buffer_load_dwordx4 v[160:163], v7, s[24:27], s66 offen offset:0 sc1
  v_mfma_f32_16x16x32_bf16 v[204:207], v[28:31], a[116:119], v[204:207]
  v_add_f32 v233, v233, v237
  v_add_f32 v241, v241, v217
  v_mfma_f32_16x16x32_bf16 v[208:211], v[28:31], a[120:123], v[208:211]
  v_add_f32 v234, v234, v238
  v_add_f32 v242, v242, v218
  v_mfma_f32_16x16x32_bf16 v[212:215], v[28:31], a[124:127], v[212:215]
  v_add_f32 v235, v235, v239
  v_add_f32 v243, v243, v219
  s_waitcnt vmcnt(12)
  v_mfma_f32_16x16x32_bf16 v[200:203], v[128:131], a[128:131], v[200:203]
  buffer_load_dwordx4 v[164:167], v7, s[24:27], s66 offen offset:1024 sc1
  v_mfma_f32_16x16x32_bf16 v[204:207], v[128:131], a[132:135], v[204:207]
  v_add_f32 v232, v232, v240
  v_add_f32 v233, v233, v241
  v_mfma_f32_16x16x32_bf16 v[208:211], v[128:131], a[136:139], v[208:211]
  v_add_f32 v234, v234, v242
  v_add_f32 v235, v235, v243
  v_mfma_f32_16x16x32_bf16 v[212:215], v[128:131], a[140:143], v[212:215]
  v_mul_f32 v232, v232, v188
  v_mul_f32 v233, v233, v189
  s_waitcnt vmcnt(12)
  v_mfma_f32_16x16x32_bf16 v[200:203], v[132:135], a[144:147], v[200:203]
  buffer_load_dwordx4 v[168:171], v7, s[24:27], s67 offen offset:0 sc1
  v_mfma_f32_16x16x32_bf16 v[204:207], v[132:135], a[148:151], v[204:207]
  v_mul_f32 v234, v234, v190
  v_mul_f32 v235, v235, v191
  v_mfma_f32_16x16x32_bf16 v[208:211], v[132:135], a[152:155], v[208:211]
  v_cvt_pk_bf16_f32 v250, v232, v233
  v_cvt_pk_bf16_f32 v251, v234, v235
  v_mfma_f32_16x16x32_bf16 v[212:215], v[132:135], a[156:159], v[212:215]
  s_waitcnt vmcnt(12)
  v_mfma_f32_16x16x32_bf16 v[200:203], v[136:139], a[160:163], v[200:203]
  buffer_load_dwordx4 v[172:175], v7, s[24:27], s67 offen offset:1024 sc1
  v_mfma_f32_16x16x32_bf16 v[204:207], v[136:139], a[164:167], v[204:207]
  v_mfma_f32_16x16x32_bf16 v[208:211], v[136:139], a[168:171], v[208:211]
  v_mfma_f32_16x16x32_bf16 v[212:215], v[136:139], a[172:175], v[212:215]
  s_waitcnt vmcnt(12)
  v_mfma_f32_16x16x32_bf16 v[200:203], v[140:143], a[176:179], v[200:203]
  buffer_load_dwordx4 v[16:19], v7, s[24:27], s68 offen offset:0 sc1
  v_mfma_f32_16x16x32_bf16 v[204:207], v[140:143], a[180:183], v[204:207]
  v_mfma_f32_16x16x32_bf16 v[208:211], v[140:143], a[184:187], v[208:211]
  v_mfma_f32_16x16x32_bf16 v[212:215], v[140:143], a[188:191], v[212:215]
  s_waitcnt vmcnt(12)
  v_mfma_f32_16x16x32_bf16 v[200:203], v[48:51], a[192:195], v[200:203]
  buffer_load_dwordx4 v[20:23], v7, s[24:27], s68 offen offset:1024 sc1
  v_mfma_f32_16x16x32_bf16 v[204:207], v[48:51], a[196:199], v[204:207]
  v_mfma_f32_16x16x32_bf16 v[208:211], v[48:51], a[200:203], v[208:211]
  v_mfma_f32_16x16x32_bf16 v[212:215], v[48:51], a[204:207], v[212:215]
  s_waitcnt vmcnt(12)
  v_mfma_f32_16x16x32_bf16 v[200:203], v[52:55], a[208:211], v[200:203]
  buffer_load_dwordx4 v[24:27], v7, s[24:27], s69 offen offset:0 sc1
  v_mfma_f32_16x16x32_bf16 v[204:207], v[52:55], a[212:215], v[204:207]
  v_mfma_f32_16x16x32_bf16 v[208:211], v[52:55], a[216:219], v[208:211]
  v_mfma_f32_16x16x32_bf16 v[212:215], v[52:55], a[220:223], v[212:215]
  s_waitcnt vmcnt(12)
  v_mfma_f32_16x16x32_bf16 v[200:203], v[56:59], a[224:227], v[200:203]
  buffer_load_dwordx4 v[28:31], v7, s[24:27], s69 offen offset:1024 sc1
  v_mfma_f32_16x16x32_bf16 v[204:207], v[56:59], a[228:231], v[204:207]
  v_mfma_f32_16x16x32_bf16 v[208:211], v[56:59], a[232:235], v[208:211]
  v_mfma_f32_16x16x32_bf16 v[212:215], v[56:59], a[236:239], v[212:215]
  s_waitcnt vmcnt(12)
  v_mfma_f32_16x16x32_bf16 v[200:203], v[60:63], a[240:243], v[200:203]
  buffer_load_dwordx4 v[128:131], v7, s[24:27], s70 offen offset:0 sc1
  v_mfma_f32_16x16x32_bf16 v[204:207], v[60:63], a[244:247], v[204:207]
  v_mfma_f32_16x16x32_bf16 v[208:211], v[60:63], a[248:251], v[208:211]
  v_mfma_f32_16x16x32_bf16 v[212:215], v[60:63], a[252:255], v[212:215]
  s_waitcnt vmcnt(12)
  v_mfma_f32_16x16x32_bf16 v[216:219], v[144:147], a[0:3], v[36:39]
  buffer_load_dwordx4 v[132:135], v7, s[24:27], s70 offen offset:1024 sc1
  v_mfma_f32_16x16x32_bf16 v[220:223], v[144:147], a[4:7], 0
  v_mfma_f32_16x16x32_bf16 v[224:227], v[144:147], a[8:11], 0
  v_mfma_f32_16x16x32_bf16 v[228:231], v[144:147], a[12:15], 0
  s_waitcnt vmcnt(12)
  v_mfma_f32_16x16x32_bf16 v[216:219], v[148:151], a[16:19], v[216:219]
  buffer_load_dwordx4 v[136:139], v7, s[24:27], s71 offen offset:0 sc1
  v_mfma_f32_16x16x32_bf16 v[220:223], v[148:151], a[20:23], v[220:223]
  ds_write_b128 v9, v[204:207] offset:0
  v_mfma_f32_16x16x32_bf16 v[224:227], v[148:151], a[24:27], v[224:227]
  ds_write_b128 v10, v[208:211] offset:0
  v_mfma_f32_16x16x32_bf16 v[228:231], v[148:151], a[28:31], v[228:231]
  ds_write_b128 v11, v[212:215] offset:0
  s_waitcnt vmcnt(12)
  v_mfma_f32_16x16x32_bf16 v[216:219], v[152:155], a[32:35], v[216:219]
  buffer_load_dwordx4 v[140:143], v7, s[24:27], s71 offen offset:1024 sc1
  v_add_u32 v7, 65536, v7
  v_mfma_f32_16x16x32_bf16 v[220:223], v[152:155], a[36:39], v[220:223]
  v_mfma_f32_16x16x32_bf16 v[224:227], v[152:155], a[40:43], v[224:227]
  v_mfma_f32_16x16x32_bf16 v[228:231], v[152:155], a[44:47], v[228:231]
  buffer_store_dwordx4 v[244:247], v0, s[20:23], s41 offen sc1
  s_add_u32 s41, s41, 131072
  buffer_store_dwordx4 v[248:251], v0, s[20:23], s41 offen sc1
  s_add_u32 s41, s41, 131072
  s_waitcnt vmcnt(14)
  v_mfma_f32_16x16x32_bf16 v[216:219], v[156:159], a[48:51], v[216:219]
  v_mfma_f32_16x16x32_bf16 v[220:223], v[156:159], a[52:55], v[220:223]
  v_mfma_f32_16x16x32_bf16 v[224:227], v[156:159], a[56:59], v[224:227]
  s_waitcnt lgkmcnt(0)
  s_barrier
  v_mfma_f32_16x16x32_bf16 v[228:231], v[156:159], a[60:63], v[228:231]
  ds_read_b128 v[232:235], v13 offset:0
  s_waitcnt vmcnt(13)
  v_mfma_f32_16x16x32_bf16 v[216:219], v[160:163], a[64:67], v[216:219]
  ds_read_b128 v[236:239], v13 offset:1024
  v_mfma_f32_16x16x32_bf16 v[220:223], v[160:163], a[68:71], v[220:223]
  ds_read_b128 v[240:243], v13 offset:2048
  v_mfma_f32_16x16x32_bf16 v[224:227], v[160:163], a[72:75], v[224:227]
  v_mfma_f32_16x16x32_bf16 v[228:231], v[160:163], a[76:79], v[228:231]
  s_waitcnt vmcnt(12)
  v_mfma_f32_16x16x32_bf16 v[216:219], v[164:167], a[80:83], v[216:219]
  v_mfma_f32_16x16x32_bf16 v[220:223], v[164:167], a[84:87], v[220:223]
  v_mfma_f32_16x16x32_bf16 v[224:227], v[164:167], a[88:91], v[224:227]
  s_waitcnt lgkmcnt(0)
  v_mfma_f32_16x16x32_bf16 v[228:231], v[164:167], a[92:95], v[228:231]
  v_add_f32 v232, v232, v236
  v_add_f32 v240, v240, v200
  s_waitcnt vmcnt(11)
  v_mfma_f32_16x16x32_bf16 v[216:219], v[168:171], a[96:99], v[216:219]
  v_add_f32 v233, v233, v237
  v_add_f32 v241, v241, v201
  v_mfma_f32_16x16x32_bf16 v[220:223], v[168:171], a[100:103], v[220:223]
  v_add_f32 v234, v234, v238
  v_add_f32 v242, v242, v202
  v_mfma_f32_16x16x32_bf16 v[224:227], v[168:171], a[104:107], v[224:227]
  v_add_f32 v235, v235, v239
  v_add_f32 v243, v243, v203
  v_mfma_f32_16x16x32_bf16 v[228:231], v[168:171], a[108:111], v[228:231]
  v_add_f32 v232, v232, v240
  v_add_f32 v233, v233, v241
  s_waitcnt vmcnt(10)
  v_mfma_f32_16x16x32_bf16 v[216:219], v[172:175], a[112:115], v[216:219]
  v_add_f32 v234, v234, v242
  v_add_f32 v235, v235, v243
  v_mfma_f32_16x16x32_bf16 v[220:223], v[172:175], a[116:119], v[220:223]
  v_mul_f32 v232, v232, v192
  v_mul_f32 v233, v233, v193
  v_mfma_f32_16x16x32_bf16 v[224:227], v[172:175], a[120:123], v[224:227]
  v_mul_f32 v234, v234, v194
  v_mul_f32 v235, v235, v195
  v_mfma_f32_16x16x32_bf16 v[228:231], v[172:175], a[124:127], v[228:231]
  v_cvt_pk_bf16_f32 v252, v232, v233
  v_cvt_pk_bf16_f32 v253, v234, v235
  s_waitcnt vmcnt(9)
  v_mfma_f32_16x16x32_bf16 v[216:219], v[16:19], a[128:131], v[216:219]
  v_mfma_f32_16x16x32_bf16 v[220:223], v[16:19], a[132:135], v[220:223]
  v_mfma_f32_16x16x32_bf16 v[224:227], v[16:19], a[136:139], v[224:227]
  v_mfma_f32_16x16x32_bf16 v[228:231], v[16:19], a[140:143], v[228:231]
  s_waitcnt vmcnt(8)
  v_mfma_f32_16x16x32_bf16 v[216:219], v[20:23], a[144:147], v[216:219]
  v_mfma_f32_16x16x32_bf16 v[220:223], v[20:23], a[148:151], v[220:223]
  v_mfma_f32_16x16x32_bf16 v[224:227], v[20:23], a[152:155], v[224:227]
  v_mfma_f32_16x16x32_bf16 v[228:231], v[20:23], a[156:159], v[228:231]
  s_waitcnt vmcnt(7)
  v_mfma_f32_16x16x32_bf16 v[216:219], v[24:27], a[160:163], v[216:219]
  v_mfma_f32_16x16x32_bf16 v[220:223], v[24:27], a[164:167], v[220:223]
  v_mfma_f32_16x16x32_bf16 v[224:227], v[24:27], a[168:171], v[224:227]
  v_mfma_f32_16x16x32_bf16 v[228:231], v[24:27], a[172:175], v[228:231]
  s_waitcnt vmcnt(6)
  v_mfma_f32_16x16x32_bf16 v[216:219], v[28:31], a[176:179], v[216:219]
  v_mfma_f32_16x16x32_bf16 v[220:223], v[28:31], a[180:183], v[220:223]
  v_mfma_f32_16x16x32_bf16 v[224:227], v[28:31], a[184:187], v[224:227]
  v_mfma_f32_16x16x32_bf16 v[228:231], v[28:31], a[188:191], v[228:231]
  s_waitcnt vmcnt(5)
  v_mfma_f32_16x16x32_bf16 v[216:219], v[128:131], a[192:195], v[216:219]
  ds_read_b128 a[0:3], v5 offset:0
  v_mfma_f32_16x16x32_bf16 v[220:223], v[128:131], a[196:199], v[220:223]
  ds_read_b128 a[4:7], v5 offset:16384
  v_mfma_f32_16x16x32_bf16 v[224:227], v[128:131], a[200:203], v[224:227]
  ds_read_b128 a[8:11], v5 offset:1024
  v_mfma_f32_16x16x32_bf16 v[228:231], v[128:131], a[204:207], v[228:231]
  ds_read_b128 a[12:15], v5 offset:17408
  s_waitcnt vmcnt(4)
  v_mfma_f32_16x16x32_bf16 v[216:219], v[132:135], a[208:211], v[216:219]
  ds_read_b128 a[16:19], v5 offset:2048
  v_mfma_f32_16x16x32_bf16 v[220:223], v[132:135], a[212:215], v[220:223]
  ds_read_b128 a[20:23], v5 offset:18432
  v_mfma_f32_16x16x32_bf16 v[224:227], v[132:135], a[216:219], v[224:227]
  ds_read_b128 a[24:27], v5 offset:3072
  v_mfma_f32_16x16x32_bf16 v[228:231], v[132:135], a[220:223], v[228:231]
  ds_read_b128 a[28:31], v5 offset:19456
  s_waitcnt vmcnt(3)
  v_mfma_f32_16x16x32_bf16 v[216:219], v[136:139], a[224:227], v[216:219]
  ds_read_b128 a[32:35], v5 offset:4096
  v_mfma_f32_16x16x32_bf16 v[220:223], v[136:139], a[228:231], v[220:223]
  ds_read_b128 a[36:39], v5 offset:20480
  v_mfma_f32_16x16x32_bf16 v[224:227], v[136:139], a[232:235], v[224:227]
  ds_read_b128 a[40:43], v5 offset:5120
  v_mfma_f32_16x16x32_bf16 v[228:231], v[136:139], a[236:239], v[228:231]
  ds_read_b128 a[44:47], v5 offset:21504
  s_waitcnt vmcnt(2)
  v_mfma_f32_16x16x32_bf16 v[216:219], v[140:143], a[240:243], v[216:219]
  v_mfma_f32_16x16x32_bf16 v[220:223], v[140:143], a[244:247], v[220:223]
  v_mfma_f32_16x16x32_bf16 v[224:227], v[140:143], a[248:251], v[224:227]
  v_mfma_f32_16x16x32_bf16 v[228:231], v[140:143], a[252:255], v[228:231]
  s_waitcnt lgkmcnt(10)
  v_mfma_f32_16x16x32_bf16 v[200:203], a[0:3], v[64:67], v[32:35]
  ds_read_b128 a[48:51], v5 offset:6144
  v_mfma_f32_16x16x32_bf16 v[204:207], a[4:7], v[64:67], v[32:35]
  ds_read_b128 a[52:55], v5 offset:22528
  s_waitcnt lgkmcnt(10)
  v_mfma_f32_16x16x32_bf16 v[208:211], a[8:11], v[68:71], 0
  ds_read_b128 a[56:59], v5 offset:7168
  v_mfma_f32_16x16x32_bf16 v[212:215], a[12:15], v[68:71], 0
  ds_read_b128 a[60:63], v5 offset:23552
  ds_write_b128 v9, v[220:223] offset:16384
  s_waitcnt lgkmcnt(11)
  v_mfma_f32_16x16x32_bf16 v[200:203], a[16:19], v[72:75], v[200:203]
  ds_read_b128 a[64:67], v5 offset:8192
  ds_write_b128 v10, v[224:227] offset:16384
  v_mfma_f32_16x16x32_bf16 v[204:207], a[20:23], v[72:75], v[204:207]
  ds_read_b128 a[68:71], v5 offset:24576
  ds_write_b128 v11, v[228:231] offset:16384
  s_waitcnt lgkmcnt(13)
  v_mfma_f32_16x16x32_bf16 v[208:211], a[24:27], v[76:79], v[208:211]
  ds_read_b128 a[72:75], v5 offset:9216
  v_mfma_f32_16x16x32_bf16 v[212:215], a[28:31], v[76:79], v[212:215]
  ds_read_b128 a[76:79], v5 offset:25600
  s_waitcnt lgkmcnt(13)
  v_mfma_f32_16x16x32_bf16 v[200:203], a[32:35], v[80:83], v[200:203]
  ds_read_b128 a[80:83], v5 offset:10240
  s_waitcnt lgkmcnt(3)
  s_barrier
  v_mfma_f32_16x16x32_bf16 v[204:207], a[36:39], v[80:83], v[204:207]
  ds_read_b128 a[84:87], v5 offset:26624
  ds_read_b128 v[232:235], v13 offset:16384
  s_waitcnt lgkmcnt(14)
  v_mfma_f32_16x16x32_bf16 v[208:211], a[40:43], v[84:87], v[208:211]
  ds_read_b128 a[88:91], v5 offset:11264
  ds_read_b128 v[236:239], v13 offset:17408
  v_mfma_f32_16x16x32_bf16 v[212:215], a[44:47], v[84:87], v[212:215]
  ds_read_b128 a[92:95], v5 offset:27648
  ds_read_b128 v[240:243], v13 offset:18432
  s_waitcnt lgkmcnt(15)
  v_mfma_f32_16x16x32_bf16 v[200:203], a[48:51], v[88:91], v[200:203]
  ds_read_b128 a[0:3], v5 offset:12288
  s_mov_b32 s36, 0
  buffer_load_dwordx4 v[144:147], v14, s[28:31], s36 offen sc1
  v_mfma_f32_16x16x32_bf16 v[204:207], a[52:55], v[88:91], v[204:207]
  ds_read_b128 a[4:7], v5 offset:28672
  s_waitcnt lgkmcnt(15)
  v_mfma_f32_16x16x32_bf16 v[208:211], a[56:59], v[92:95], v[208:211]
  ds_read_b128 a[8:11], v5 offset:13312
  s_mov_b32 s36, 393216
  buffer_load_dwordx4 v[148:151], v14, s[28:31], s36 offen sc1
  v_mfma_f32_16x16x32_bf16 v[212:215], a[60:63], v[92:95], v[212:215]
  ds_read_b128 a[12:15], v5 offset:29696
  s_waitcnt lgkmcnt(4)
  s_waitcnt lgkmcnt(14)
  v_mfma_f32_16x16x32_bf16 v[200:203], a[64:67], v[96:99], v[200:203]
  ds_read_b128 a[16:19], v5 offset:14336
  v_add_f32 v232, v232, v236
  v_add_f32 v240, v240, v216
  s_mov_b32 s36, 786432
  buffer_load_dwordx4 v[152:155], v14, s[28:31], s36 offen sc1
  v_mfma_f32_16x16x32_bf16 v[204:207], a[68:71], v[96:99], v[204:207]
  ds_read_b128 a[20:23], v5 offset:30720
  v_add_f32 v233, v233, v237
  v_add_f32 v241, v241, v217
  s_waitcnt lgkmcnt(13)
  v_mfma_f32_16x16x32_bf16 v[208:211], a[72:75], v[100:103], v[208:211]
  ds_read_b128 a[24:27], v5 offset:15360
  v_add_f32 v234, v234, v238
  v_add_f32 v242, v242, v218
  s_mov_b32 s36, 1179648
  buffer_load_dwordx4 v[156:159], v14, s[28:31], s36 offen sc1
  v_mfma_f32_16x16x32_bf16 v[212:215], a[76:79], v[100:103], v[212:215]
  ds_read_b128 a[28:31], v5 offset:31744
  v_add_f32 v235, v235, v239
  v_add_f32 v243, v243, v219
  s_waitcnt lgkmcnt(13)
  v_mfma_f32_16x16x32_bf16 v[200:203], a[80:83], v[104:107], v[200:203]
  ds_read_b128 a[32:35], v0 offset:0
  v_add_f32 v232, v232, v240
  v_add_f32 v233, v233, v241
  s_mov_b32 s36, 1441792
  buffer_load_dwordx4 v[160:163], v14, s[28:31], s36 offen sc1
  v_mfma_f32_16x16x32_bf16 v[204:207], a[84:87], v[104:107], v[204:207]
  ds_read_b128 a[36:39], v0 offset:22528
  v_add_f32 v234, v234, v242
  v_add_f32 v235, v235, v243
  s_waitcnt lgkmcnt(11)
  v_mfma_f32_16x16x32_bf16 v[208:211], a[88:91], v[108:111], v[208:211]
  ds_read_b128 a[40:43], v6 offset:0
  v_mul_f32 v232, v232, v196
  v_mul_f32 v233, v233, v197
  s_mov_b32 s36, 1835008
  buffer_load_dwordx4 v[164:167], v14, s[28:31], s36 offen sc1
  v_mfma_f32_16x16x32_bf16 v[212:215], a[92:95], v[108:111], v[212:215]
  ds_read_b128 a[44:47], v6 offset:22528
  v_mul_f32 v234, v234, v198
  v_mul_f32 v235, v235, v199
  s_waitcnt lgkmcnt(10)
  v_mfma_f32_16x16x32_bf16 v[200:203], a[0:3], v[112:115], v[200:203]
  ds_read_b128 a[48:51], v0 offset:3072
  v_cvt_pk_bf16_f32 v254, v232, v233
  v_cvt_pk_bf16_f32 v255, v234, v235
  s_mov_b32 s36, 2228224
  buffer_load_dwordx4 v[168:171], v14, s[28:31], s36 offen sc1
  v_mfma_f32_16x16x32_bf16 v[204:207], a[4:7], v[112:115], v[204:207]
  ds_read_b128 a[52:55], v0 offset:25600
  buffer_store_dwordx4 v[252:255], v0, s[20:23], s41 offen sc1
  s_add_u32 s41, s41, 131072
  s_waitcnt lgkmcnt(10)
  v_mfma_f32_16x16x32_bf16 v[208:211], a[8:11], v[116:119], v[208:211]
  ds_read_b128 a[56:59], v6 offset:3072
  s_mov_b32 s36, 2621440
  buffer_load_dwordx4 v[172:175], v14, s[28:31], s36 offen sc1
  v_mfma_f32_16x16x32_bf16 v[212:215], a[12:15], v[116:119], v[212:215]
  ds_read_b128 a[60:63], v6 offset:25600
  s_waitcnt lgkmcnt(10)
  v_mfma_f32_16x16x32_bf16 v[200:203], a[16:19], v[120:123], v[200:203]
  ds_read_b128 a[64:67], v0 offset:6144
  s_mov_b32 s36, 131072
  buffer_load_dwordx4 v[16:19], v14, s[28:31], s36 offen sc1
  v_mfma_f32_16x16x32_bf16 v[204:207], a[20:23], v[120:123], v[204:207]
  ds_read_b128 a[68:71], v0 offset:28672
  s_waitcnt lgkmcnt(10)
  v_mfma_f32_16x16x32_bf16 v[208:211], a[24:27], v[124:127], v[208:211]
  ds_read_b128 a[72:75], v6 offset:6144
  s_mov_b32 s36, 524288
  buffer_load_dwordx4 v[20:23], v14, s[28:31], s36 offen sc1
  v_mfma_f32_16x16x32_bf16 v[212:215], a[28:31], v[124:127], v[212:215]
  ds_read_b128 a[76:79], v6 offset:28672
  s_nop 2
  v_pk_add_f32 v[216:217], v[200:201], v[208:209]
  v_pk_add_f32 v[224:225], v[200:201], v[208:209] neg_lo:[0,1] neg_hi:[0,1]
  v_pk_add_f32 v[218:219], v[202:203], v[210:211]
  v_pk_add_f32 v[226:227], v[202:203], v[210:211] neg_lo:[0,1] neg_hi:[0,1]
  v_pk_add_f32 v[220:221], v[204:205], v[212:213]
  v_pk_add_f32 v[228:229], v[204:205], v[212:213] neg_lo:[0,1] neg_hi:[0,1]
  v_pk_add_f32 v[222:223], v[206:207], v[214:215]
  v_pk_add_f32 v[230:231], v[206:207], v[214:215] neg_lo:[0,1] neg_hi:[0,1]
  s_waitcnt vmcnt(7)
  v_max3_u32 v40, v147, v151, v155
  v_max_u32 v40, v40, v159
  v_cmp_eq_u32 vcc, -1, v40
  s_nop 0
  s_cbranch_vccnz p0_slow
p0_ok:
  s_waitcnt lgkmcnt(10)
  v_mfma_f32_16x16x32_bf16 v[216:219], a[32:35], v[144:147], v[216:219]
  ds_read_b128 a[80:83], v0 offset:9216
  s_mov_b32 s36, 917504
  buffer_load_dwordx4 v[24:27], v14, s[28:31], s36 offen sc1
  v_mfma_f32_16x16x32_bf16 v[220:223], a[36:39], v[144:147], v[220:223]
  ds_read_b128 a[84:87], v0 offset:31744
  s_waitcnt lgkmcnt(10)
  v_mfma_f32_16x16x32_bf16 v[224:227], a[40:43], v[144:147], v[224:227]
  ds_read_b128 a[88:91], v6 offset:9216
  s_mov_b32 s36, 1310720
  buffer_load_dwordx4 v[28:31], v14, s[28:31], s36 offen sc1
  v_mfma_f32_16x16x32_bf16 v[228:231], a[44:47], v[144:147], v[228:231]
  ds_read_b128 a[92:95], v6 offset:31744
  s_waitcnt lgkmcnt(10)
  v_mfma_f32_16x16x32_bf16 v[216:219], a[48:51], v[148:151], v[216:219]
  ds_read_b128 a[0:3], v0 offset:11264
  s_mov_b32 s36, 1572864
  buffer_load_dwordx4 v[128:131], v14, s[28:31], s36 offen sc1
  v_mfma_f32_16x16x32_bf16 v[220:223], a[52:55], v[148:151], v[220:223]
  ds_read_b128 a[4:7], v0 offset:33792
  s_waitcnt lgkmcnt(10)
  v_mfma_f32_16x16x32_bf16 v[224:227], a[56:59], v[148:151], v[224:227]
  ds_read_b128 a[8:11], v6 offset:11264
  s_mov_b32 s36, 1966080
  buffer_load_dwordx4 v[132:135], v14, s[28:31], s36 offen sc1
  v_mfma_f32_16x16x32_bf16 v[228:231], a[60:63], v[148:151], v[228:231]
  ds_read_b128 a[12:15], v6 offset:33792
  s_waitcnt lgkmcnt(10)
  v_mfma_f32_16x16x32_bf16 v[216:219], a[64:67], v[152:155], v[216:219]
  ds_read_b128 a[16:19], v0 offset:14336
  s_mov_b32 s36, 2359296
  buffer_load_dwordx4 v[136:139], v14, s[28:31], s36 offen sc1
  v_mfma_f32_16x16x32_bf16 v[220:223], a[68:71], v[152:155], v[220:223]
  ds_read_b128 a[20:23], v0 offset:36864
  s_waitcnt lgkmcnt(10)
  v_mfma_f32_16x16x32_bf16 v[224:227], a[72:75], v[152:155], v[224:227]
  ds_read_b128 a[24:27], v6 offset:14336
  s_mov_b32 s36, 2752512
  buffer_load_dwordx4 v[140:143], v14, s[28:31], s36 offen sc1
  v_mfma_f32_16x16x32_bf16 v[228:231], a[76:79], v[152:155], v[228:231]
  ds_read_b128 a[28:31], v6 offset:36864
  s_waitcnt lgkmcnt(10)
  v_mfma_f32_16x16x32_bf16 v[216:219], a[80:83], v[156:159], v[216:219]
  ds_read_b128 a[32:35], v0 offset:17408
  v_mfma_f32_16x16x32_bf16 v[220:223], a[84:87], v[156:159], v[220:223]
  ds_read_b128 a[36:39], v0 offset:39936
  s_waitcnt vmcnt(8)
  v_max3_u32 v40, v163, v167, v171
  v_max_u32 v40, v40, v175
  s_waitcnt lgkmcnt(10)
  v_mfma_f32_16x16x32_bf16 v[224:227], a[88:91], v[156:159], v[224:227]
  ds_read_b128 a[40:43], v6 offset:17408
  v_cmp_eq_u32 vcc, -1, v40
  v_mfma_f32_16x16x32_bf16 v[228:231], a[92:95], v[156:159], v[228:231]
  ds_read_b128 a[44:47], v6 offset:39936
  s_cbranch_vccnz p1_slow
p1_ok:
  s_waitcnt lgkmcnt(10)
  v_mfma_f32_16x16x32_bf16 v[216:219], a[0:3], v[160:163], v[216:219]
  ds_read_b128 a[48:51], v0 offset:20480
  v_mfma_f32_16x16x32_bf16 v[220:223], a[4:7], v[160:163], v[220:223]
  ds_read_b128 a[52:55], v0 offset:43008
  s_waitcnt lgkmcnt(10)
  v_mfma_f32_16x16x32_bf16 v[224:227], a[8:11], v[160:163], v[224:227]
  ds_read_b128 a[56:59], v6 offset:20480
  v_mfma_f32_16x16x32_bf16 v[228:231], a[12:15], v[160:163], v[228:231]
  ds_read_b128 a[60:63], v6 offset:43008
  s_waitcnt lgkmcnt(10)
  v_mfma_f32_16x16x32_bf16 v[216:219], a[16:19], v[164:167], v[216:219]
  ds_read_b128 a[64:67], v0 offset:1024
  v_mfma_f32_16x16x32_bf16 v[220:223], a[20:23], v[164:167], v[220:223]
  ds_read_b128 a[68:71], v0 offset:23552
  s_waitcnt lgkmcnt(10)
  v_mfma_f32_16x16x32_bf16 v[224:227], a[24:27], v[164:167], v[224:227]
  ds_read_b128 a[72:75], v6 offset:1024
  v_mfma_f32_16x16x32_bf16 v[228:231], a[28:31], v[164:167], v[228:231]
  ds_read_b128 a[76:79], v6 offset:23552
  s_waitcnt lgkmcnt(10)
  v_mfma_f32_16x16x32_bf16 v[216:219], a[32:35], v[168:171], v[216:219]
  ds_read_b128 a[80:83], v0 offset:4096
  s_mov_b32 s36, 262144
  buffer_load_dwordx4 v[48:51], v14, s[28:31], s36 offen sc1
  v_mfma_f32_16x16x32_bf16 v[220:223], a[36:39], v[168:171], v[220:223]
  ds_read_b128 a[84:87], v0 offset:26624
  s_waitcnt lgkmcnt(10)
  v_mfma_f32_16x16x32_bf16 v[224:227], a[40:43], v[168:171], v[224:227]
  ds_read_b128 a[88:91], v6 offset:4096
  s_mov_b32 s36, 655360
  buffer_load_dwordx4 v[52:55], v14, s[28:31], s36 offen sc1
  v_mfma_f32_16x16x32_bf16 v[228:231], a[44:47], v[168:171], v[228:231]
  ds_read_b128 a[92:95], v6 offset:26624
  s_waitcnt lgkmcnt(10)
  v_mfma_f32_16x16x32_bf16 v[216:219], a[48:51], v[172:175], v[216:219]
  ds_read_b128 a[0:3], v0 offset:7168
  s_mov_b32 s36, 1048576
  buffer_load_dwordx4 v[56:59], v14, s[28:31], s36 offen sc1
  v_mfma_f32_16x16x32_bf16 v[220:223], a[52:55], v[172:175], v[220:223]
  ds_read_b128 a[4:7], v0 offset:29696
  s_waitcnt vmcnt(7)
  v_max3_u32 v40, v19, v23, v27
  v_max_u32 v40, v40, v31
  s_waitcnt lgkmcnt(10)
  v_mfma_f32_16x16x32_bf16 v[224:227], a[56:59], v[172:175], v[224:227]
  ds_read_b128 a[8:11], v6 offset:7168
  v_cmp_eq_u32 vcc, -1, v40
  v_mfma_f32_16x16x32_bf16 v[228:231], a[60:63], v[172:175], v[228:231]
  ds_read_b128 a[12:15], v6 offset:29696
  s_cbranch_vccnz p2_slow
p2_ok:
  s_waitcnt lgkmcnt(10)
  v_mfma_f32_16x16x32_bf16 v[216:219], a[64:67], v[16:19], v[216:219]
  ds_read_b128 a[16:19], v0 offset:10240
  s_mov_b32 s36, 1703936
  buffer_load_dwordx4 v[60:63], v14, s[28:31], s36 offen sc1
  v_mfma_f32_16x16x32_bf16 v[220:223], a[68:71], v[16:19], v[220:223]
  ds_read_b128 a[20:23], v0 offset:32768
  s_waitcnt lgkmcnt(10)
  v_mfma_f32_16x16x32_bf16 v[224:227], a[72:75], v[16:19], v[224:227]
  ds_read_b128 a[24:27], v6 offset:10240
  s_mov_b32 s36, 2097152
  buffer_load_dwordx4 v[176:179], v14, s[28:31], s36 offen sc1
  v_mfma_f32_16x16x32_bf16 v[228:231], a[76:79], v[16:19], v[228:231]
  ds_read_b128 a[28:31], v6 offset:32768
  s_waitcnt lgkmcnt(10)
  v_mfma_f32_16x16x32_bf16 v[216:219], a[80:83], v[20:23], v[216:219]
  ds_read_b128 a[32:35], v0 offset:12288
  s_mov_b32 s36, 2490368
  buffer_load_dwordx4 v[180:183], v14, s[28:31], s36 offen sc1
  v_mfma_f32_16x16x32_bf16 v[220:223], a[84:87], v[20:23], v[220:223]
  ds_read_b128 a[36:39], v0 offset:34816
  s_waitcnt lgkmcnt(10)
  v_mfma_f32_16x16x32_bf16 v[224:227], a[88:91], v[20:23], v[224:227]
  ds_read_b128 a[40:43], v6 offset:12288
  v_mfma_f32_16x16x32_bf16 v[228:231], a[92:95], v[20:23], v[228:231]
  ds_read_b128 a[44:47], v6 offset:34816
  s_waitcnt lgkmcnt(10)
  v_mfma_f32_16x16x32_bf16 v[216:219], a[0:3], v[24:27], v[216:219]
  ds_read_b128 a[48:51], v0 offset:15360
  v_mfma_f32_16x16x32_bf16 v[220:223], a[4:7], v[24:27], v[220:223]
  ds_read_b128 a[52:55], v0 offset:37888
  s_waitcnt lgkmcnt(10)
  v_mfma_f32_16x16x32_bf16 v[224:227], a[8:11], v[24:27], v[224:227]
  ds_read_b128 a[56:59], v6 offset:15360
  v_mfma_f32_16x16x32_bf16 v[228:231], a[12:15], v[24:27], v[228:231]
  ds_read_b128 a[60:63], v6 offset:37888
  s_waitcnt lgkmcnt(10)
  v_mfma_f32_16x16x32_bf16 v[216:219], a[16:19], v[28:31], v[216:219]
  ds_read_b128 a[64:67], v0 offset:18432
  v_mfma_f32_16x16x32_bf16 v[220:223], a[20:23], v[28:31], v[220:223]
  ds_read_b128 a[68:71], v0 offset:40960
  s_waitcnt vmcnt(6)
  v_max3_u32 v40, v131, v135, v139
  v_max_u32 v40, v40, v143
  s_waitcnt lgkmcnt(10)
  v_mfma_f32_16x16x32_bf16 v[224:227], a[24:27], v[28:31], v[224:227]
  ds_read_b128 a[72:75], v6 offset:18432
  v_cmp_eq_u32 vcc, -1, v40
  v_mfma_f32_16x16x32_bf16 v[228:231], a[28:31], v[28:31], v[228:231]
  ds_read_b128 a[76:79], v6 offset:40960
  s_cbranch_vccnz p3_slow
p3_ok:
  s_waitcnt lgkmcnt(10)
  v_mfma_f32_16x16x32_bf16 v[216:219], a[32:35], v[128:131], v[216:219]
  ds_read_b128 a[80:83], v0 offset:21504
  v_mfma_f32_16x16x32_bf16 v[220:223], a[36:39], v[128:131], v[220:223]
  ds_read_b128 a[84:87], v0 offset:44032
  s_waitcnt lgkmcnt(10)
  v_mfma_f32_16x16x32_bf16 v[224:227], a[40:43], v[128:131], v[224:227]
  ds_read_b128 a[88:91], v6 offset:21504
  v_mfma_f32_16x16x32_bf16 v[228:231], a[44:47], v[128:131], v[228:231]
  ds_read_b128 a[92:95], v6 offset:44032
  s_waitcnt lgkmcnt(10)
  v_mfma_f32_16x16x32_bf16 v[216:219], a[48:51], v[132:135], v[216:219]
  ds_read_b128 a[0:3], v0 offset:2048
  v_mfma_f32_16x16x32_bf16 v[220:223], a[52:55], v[132:135], v[220:223]
  ds_read_b128 a[4:7], v0 offset:24576
  s_waitcnt lgkmcnt(10)
  v_mfma_f32_16x16x32_bf16 v[224:227], a[56:59], v[132:135], v[224:227]
  ds_read_b128 a[8:11], v6 offset:2048
  v_mfma_f32_16x16x32_bf16 v[228:231], a[60:63], v[132:135], v[228:231]
  ds_read_b128 a[12:15], v6 offset:24576
  s_waitcnt lgkmcnt(10)
  v_mfma_f32_16x16x32_bf16 v[216:219], a[64:67], v[136:139], v[216:219]
  ds_read_b128 a[16:19], v0 offset:5120
  v_mfma_f32_16x16x32_bf16 v[220:223], a[68:71], v[136:139], v[220:223]
  ds_read_b128 a[20:23], v0 offset:27648
  s_waitcnt lgkmcnt(10)
  v_mfma_f32_16x16x32_bf16 v[224:227], a[72:75], v[136:139], v[224:227]
  ds_read_b128 a[24:27], v6 offset:5120
  v_mfma_f32_16x16x32_bf16 v[228:231], a[76:79], v[136:139], v[228:231]
  ds_read_b128 a[28:31], v6 offset:27648
  s_waitcnt lgkmcnt(10)
  v_mfma_f32_16x16x32_bf16 v[216:219], a[80:83], v[140:143], v[216:219]
  ds_read_b128 a[32:35], v0 offset:8192
  v_mfma_f32_16x16x32_bf16 v[220:223], a[84:87], v[140:143], v[220:223]
  ds_read_b128 a[36:39], v0 offset:30720
  s_waitcnt vmcnt(3)
  v_max3_u32 v40, v51, v55, v59
  s_waitcnt lgkmcnt(10)
  v_mfma_f32_16x16x32_bf16 v[224:227], a[88:91], v[140:143], v[224:227]
  ds_read_b128 a[40:43], v6 offset:8192
  v_cmp_eq_u32 vcc, -1, v40
  v_mfma_f32_16x16x32_bf16 v[228:231], a[92:95], v[140:143], v[228:231]
  ds_read_b128 a[44:47], v6 offset:30720
  s_cbranch_vccnz p4_slow
p4_ok:
  s_waitcnt lgkmcnt(10)
  v_mfma_f32_16x16x32_bf16 v[216:219], a[0:3], v[48:51], v[216:219]
  ds_read_b128 a[48:51], v0 offset:13312
  v_mfma_f32_16x16x32_bf16 v[220:223], a[4:7], v[48:51], v[220:223]
  ds_read_b128 a[52:55], v0 offset:35840
  s_waitcnt lgkmcnt(10)
  v_mfma_f32_16x16x32_bf16 v[224:227], a[8:11], v[48:51], v[224:227]
  ds_read_b128 a[56:59], v6 offset:13312
  v_mfma_f32_16x16x32_bf16 v[228:231], a[12:15], v[48:51], v[228:231]
  ds_read_b128 a[60:63], v6 offset:35840
  s_waitcnt lgkmcnt(10)
  v_mfma_f32_16x16x32_bf16 v[216:219], a[16:19], v[52:55], v[216:219]
  ds_read_b128 a[64:67], v0 offset:16384
  v_mfma_f32_16x16x32_bf16 v[220:223], a[20:23], v[52:55], v[220:223]
  ds_read_b128 a[68:71], v0 offset:38912
  s_waitcnt lgkmcnt(10)
  v_mfma_f32_16x16x32_bf16 v[224:227], a[24:27], v[52:55], v[224:227]
  ds_read_b128 a[72:75], v6 offset:16384
  v_mfma_f32_16x16x32_bf16 v[228:231], a[28:31], v[52:55], v[228:231]
  ds_read_b128 a[76:79], v6 offset:38912
  s_waitcnt lgkmcnt(10)
  v_mfma_f32_16x16x32_bf16 v[216:219], a[32:35], v[56:59], v[216:219]
  ds_read_b128 a[80:83], v0 offset:19456
  v_mfma_f32_16x16x32_bf16 v[220:223], a[36:39], v[56:59], v[220:223]
  ds_read_b128 a[84:87], v0 offset:41984
  s_waitcnt vmcnt(0)
  v_max3_u32 v40, v63, v179, v183
  s_waitcnt lgkmcnt(10)
  v_mfma_f32_16x16x32_bf16 v[224:227], a[40:43], v[56:59], v[224:227]
  ds_read_b128 a[88:91], v6 offset:19456
  v_cmp_eq_u32 vcc, -1, v40
  v_mfma_f32_16x16x32_bf16 v[228:231], a[44:47], v[56:59], v[228:231]
  ds_read_b128 a[92:95], v6 offset:41984
  s_cbranch_vccnz p5_slow
p5_ok:
  s_waitcnt lgkmcnt(10)
  v_mfma_f32_16x16x32_bf16 v[216:219], a[48:51], v[60:63], v[216:219]
  v_mfma_f32_16x16x32_bf16 v[220:223], a[52:55], v[60:63], v[220:223]
  s_waitcnt lgkmcnt(8)
  v_mfma_f32_16x16x32_bf16 v[224:227], a[56:59], v[60:63], v[224:227]
  v_mfma_f32_16x16x32_bf16 v[228:231], a[60:63], v[60:63], v[228:231]
  s_waitcnt lgkmcnt(6)
  v_mfma_f32_16x16x32_bf16 v[216:219], a[64:67], v[176:179], v[216:219]
  v_mfma_f32_16x16x32_bf16 v[220:223], a[68:71], v[176:179], v[220:223]
  s_waitcnt lgkmcnt(4)
  v_mfma_f32_16x16x32_bf16 v[224:227], a[72:75], v[176:179], v[224:227]
  v_mfma_f32_16x16x32_bf16 v[228:231], a[76:79], v[176:179], v[228:231]
  s_waitcnt lgkmcnt(2)
  v_mfma_f32_16x16x32_bf16 v[216:219], a[80:83], v[180:183], v[216:219]
  v_mfma_f32_16x16x32_bf16 v[220:223], a[84:87], v[180:183], v[220:223]
  s_waitcnt lgkmcnt(0)
  v_mfma_f32_16x16x32_bf16 v[224:227], a[88:91], v[180:183], v[224:227]
  v_mfma_f32_16x16x32_bf16 v[228:231], a[92:95], v[180:183], v[228:231]
  s_lshl_b32 s36, s57, 6
  s_nop 2
  v_cvt_pk_bf16_f32 v40, v216, v217
  v_cvt_pk_bf16_f32 v41, v218, v219
  v_cvt_pk_bf16_f32 v42, v220, v221
  v_cvt_pk_bf16_f32 v43, v222, v223
  v_cvt_pk_bf16_f32 v44, v224, v225
  v_cvt_pk_bf16_f32 v45, v226, v227
  v_cvt_pk_bf16_f32 v46, v228, v229
  v_cvt_pk_bf16_f32 v47, v230, v231
  buffer_store_dwordx4 v[40:43], v12, s[48:51], s36 offen
  buffer_store_dwordx4 v[44:47], v12, s[48:51], s36 offen offset:512
  s_nop 1
k_done:
  s_endpgm
g_slow:
  s_mov_b32 s43, 0
g_loop:
  s_add_u32 m0, s71, 0
  s_add_u32 s42, s41, 0
  buffer_load_dwordx4 v5, s[8:11], s42 offen sc1 lds
  s_add_u32 m0, s71, 1024
  s_add_u32 s42, s41, 262144
  buffer_load_dwordx4 v5, s[8:11], s42 offen sc1 lds
  s_add_u32 m0, s71, 2048
  s_add_u32 s42, s41, 524288
  buffer_load_dwordx4 v5, s[8:11], s42 offen sc1 lds
  s_add_u32 m0, s71, 3072
  s_add_u32 s42, s41, 786432
  buffer_load_dwordx4 v5, s[8:11], s42 offen sc1 lds
  s_waitcnt vmcnt(0)
  ds_read_b128 v[64:67], v232 offset:0
  ds_read_b128 v[68:71], v232 offset:256
  s_waitcnt lgkmcnt(0)
  v_xor_b32 v12, v64, v250
  v_bitop3_b32 v12, v65, v251, v12 bitop3:0xbe
  v_bitop3_b32 v12, v66, v252, v12 bitop3:0xbe
  v_bitop3_b32 v12, v67, v253, v12 bitop3:0xbe
  v_bitop3_b32 v12, v68, v250, v12 bitop3:0xbe
  v_bitop3_b32 v12, v69, v251, v12 bitop3:0xbe
  v_bitop3_b32 v12, v70, v252, v12 bitop3:0xbe
  v_bitop3_b32 v12, v71, v253, v12 bitop3:0xbe
  v_and_b32 v12, 0x30003, v12
  v_cmp_ne_u32 vcc, 0, v12
  s_add_u32 s43, s43, 1
  s_cmp_ge_u32 s43, 100000
  s_nop 1
  s_cbranch_scc1 g_ok
  s_cbranch_vccnz g_loop
  s_branch g_ok
s_slow:
  s_mov_b32 s43, 0
s_loop:
  s_mov_b32 m0, s70
  s_add_u32 s42, s61, 3072
  buffer_load_dwordx4 v249, s[8:11], s61 offen sc1 lds
  buffer_load_dwordx4 v249, s[8:11], s42 offen offset:1024 sc1 lds
  s_waitcnt vmcnt(0)
  ds_read_b64 v[104:105], v8 offset:0
  ds_read_b64 v[106:107], v8 offset:32
  ds_read_b64 v[108:109], v8 offset:128
  ds_read_b64 v[110:111], v8 offset:160
  s_waitcnt lgkmcnt(0)
  v_xor_b32_e64 v13, v104, v254
  v_bitop3_b32 v13, v105, v255, v13 bitop3:0xbe
  v_bitop3_b32 v13, v106, v254, v13 bitop3:0xbe
  v_bitop3_b32 v13, v107, v255, v13 bitop3:0xbe
  v_bitop3_b32 v13, v108, v254, v13 bitop3:0xbe
  v_bitop3_b32 v13, v109, v255, v13 bitop3:0xbe
  v_bitop3_b32 v13, v110, v254, v13 bitop3:0xbe
  v_bitop3_b32 v13, v111, v255, v13 bitop3:0xbe
  v_and_b32 v13, 15, v13
  v_cmp_ne_u32 vcc, 0, v13
  s_add_u32 s43, s43, 1
  s_cmp_ge_u32 s43, 100000
  s_nop 1
  s_cbranch_scc1 s_ok
  s_cbranch_vccnz s_loop
  s_branch s_ok
h_slow:
  s_mov_b32 s43, 0
h_loop:
  buffer_load_dword v15, v7, s[8:11], s36 offen sc1
  s_waitcnt vmcnt(0)
  v_cmp_ne_u32 vcc, s4, v15
  s_add_u32 s43, s43, 1
  s_cmp_ge_u32 s43, 100000
  s_nop 1
  s_cbranch_scc1 h_ok
  s_cbranch_vccnz h_loop
  s_branch h_ok
st_slow:
  s_mov_b32 s43, 0
st_loop:
  buffer_load_dwordx4 v[144:147], v0, s[8:11], s39 offen offset:0 sc1
  buffer_load_dwordx4 v[148:151], v0, s[8:11], s39 offen offset:1024 sc1
  buffer_load_dwordx4 v[152:155], v0, s[8:11], s39 offen offset:2048 sc1
  buffer_load_dwordx4 v[156:159], v0, s[8:11], s39 offen offset:3072 sc1
  s_waitcnt vmcnt(0)
  v_max3_u32 v15, v144, v148, v152
  v_max3_u32 v15, v15, v156, v147
  v_max3_u32 v15, v15, v151, v155
  v_max_u32 v15, v15, v159
  v_cmp_eq_u32 vcc, -1, v15
  s_add_u32 s43, s43, 1
  s_cmp_ge_u32 s43, 100000
  s_nop 1
  s_cbranch_scc1 st_ok
  s_cbranch_vccnz st_loop
  s_branch st_ok
z_slow:
  s_mov_b32 s43, 0
z_loop:
  buffer_load_dword v40, v8, s[8:11], s38 offen sc1
  s_waitcnt vmcnt(0)
  v_cmp_ne_u32 vcc, s4, v40
  s_add_u32 s43, s43, 1
  s_cmp_ge_u32 s43, 100000
  s_nop 1
  s_cbranch_scc1 z_ok
  s_cbranch_vccnz z_loop
  s_branch z_ok
p0_slow:
  s_mov_b32 s43, 0
p0_loop:
  s_mov_b32 s36, 0
  buffer_load_dwordx4 v[144:147], v14, s[28:31], s36 offen sc1
  s_mov_b32 s36, 393216
  buffer_load_dwordx4 v[148:151], v14, s[28:31], s36 offen sc1
  s_mov_b32 s36, 786432
  buffer_load_dwordx4 v[152:155], v14, s[28:31], s36 offen sc1
  s_mov_b32 s36, 1179648
  buffer_load_dwordx4 v[156:159], v14, s[28:31], s36 offen sc1
  s_add_u32 s43, s43, 1
  s_waitcnt vmcnt(0)
  v_max3_u32 v40, v147, v151, v155
  v_max_u32 v40, v40, v159
  v_cmp_eq_u32 vcc, -1, v40
  s_cmp_ge_u32 s43, 100000
  s_nop 2
  s_cbranch_scc1 p0_ok
  s_cbranch_vccnz p0_loop
  s_branch p0_ok
p1_slow:
  s_mov_b32 s43, 0
p1_loop:
  s_mov_b32 s36, 1441792
  buffer_load_dwordx4 v[160:163], v14, s[28:31], s36 offen sc1
  s_mov_b32 s36, 1835008
  buffer_load_dwordx4 v[164:167], v14, s[28:31], s36 offen sc1
  s_mov_b32 s36, 2228224
  buffer_load_dwordx4 v[168:171], v14, s[28:31], s36 offen sc1
  s_mov_b32 s36, 2621440
  buffer_load_dwordx4 v[172:175], v14, s[28:31], s36 offen sc1
  s_add_u32 s43, s43, 1
  s_waitcnt vmcnt(0)
  v_max3_u32 v40, v163, v167, v171
  v_max_u32 v40, v40, v175
  v_cmp_eq_u32 vcc, -1, v40
  s_cmp_ge_u32 s43, 100000
  s_nop 2
  s_cbranch_scc1 p1_ok
  s_cbranch_vccnz p1_loop
  s_branch p1_ok
p2_slow:
  s_mov_b32 s43, 0
p2_loop:
  s_mov_b32 s36, 131072
  buffer_load_dwordx4 v[16:19], v14, s[28:31], s36 offen sc1
  s_mov_b32 s36, 524288
  buffer_load_dwordx4 v[20:23], v14, s[28:31], s36 offen sc1
  s_mov_b32 s36, 917504
  buffer_load_dwordx4 v[24:27], v14, s[28:31], s36 offen sc1
  s_mov_b32 s36, 1310720
  buffer_load_dwordx4 v[28:31], v14, s[28:31], s36 offen sc1
  s_add_u32 s43, s43, 1
  s_waitcnt vmcnt(0)
  v_max3_u32 v40, v19, v23, v27
  v_max_u32 v40, v40, v31
  v_cmp_eq_u32 vcc, -1, v40
  s_cmp_ge_u32 s43, 100000
  s_nop 2
  s_cbranch_scc1 p2_ok
  s_cbranch_vccnz p2_loop
  s_branch p2_ok
p3_slow:
  s_mov_b32 s43, 0
p3_loop:
  s_mov_b32 s36, 1572864
  buffer_load_dwordx4 v[128:131], v14, s[28:31], s36 offen sc1
  s_mov_b32 s36, 1966080
  buffer_load_dwordx4 v[132:135], v14, s[28:31], s36 offen sc1
  s_mov_b32 s36, 2359296
  buffer_load_dwordx4 v[136:139], v14, s[28:31], s36 offen sc1
  s_mov_b32 s36, 2752512
  buffer_load_dwordx4 v[140:143], v14, s[28:31], s36 offen sc1
  s_add_u32 s43, s43, 1
  s_waitcnt vmcnt(0)
  v_max3_u32 v40, v131, v135, v139
  v_max_u32 v40, v40, v143
  v_cmp_eq_u32 vcc, -1, v40
  s_cmp_ge_u32 s43, 100000
  s_nop 2
  s_cbranch_scc1 p3_ok
  s_cbranch_vccnz p3_loop
  s_branch p3_ok
p4_slow:
  s_mov_b32 s43, 0
p4_loop:
  s_mov_b32 s36, 262144
  buffer_load_dwordx4 v[48:51], v14, s[28:31], s36 offen sc1
  s_mov_b32 s36, 655360
  buffer_load_dwordx4 v[52:55], v14, s[28:31], s36 offen sc1
  s_mov_b32 s36, 1048576
  buffer_load_dwordx4 v[56:59], v14, s[28:31], s36 offen sc1
  s_add_u32 s43, s43, 1
  s_waitcnt vmcnt(0)
  v_max3_u32 v40, v51, v55, v59
  v_cmp_eq_u32 vcc, -1, v40
  s_cmp_ge_u32 s43, 100000
  s_nop 2
  s_cbranch_scc1 p4_ok
  s_cbranch_vccnz p4_loop
  s_branch p4_ok
p5_slow:
  s_mov_b32 s43, 0
p5_loop:
  s_mov_b32 s36, 1703936
  buffer_load_dwordx4 v[60:63], v14, s[28:31], s36 offen sc1
  s_mov_b32 s36, 2097152
  buffer_load_dwordx4 v[176:179], v14, s[28:31], s36 offen sc1
  s_mov_b32 s36, 2490368
  buffer_load_dwordx4 v[180:183], v14, s[28:31], s36 offen sc1
  s_add_u32 s43, s43, 1
  s_waitcnt vmcnt(0)
  v_max3_u32 v40, v63, v179, v183
  v_cmp_eq_u32 vcc, -1, v40
  s_cmp_ge_u32 s43, 100000
  s_nop 2
  s_cbranch_scc1 p5_ok
  s_cbranch_vccnz p5_loop
  s_branch p5_ok
.fill 4096, 4, 0
.section .rodata,"a"
.p2align 6
.amdhsa_kernel sequential_preLN__spectral_gfnet__mixer_gmlp__prompt_kernel
  .amdhsa_next_free_vgpr 512
  .amdhsa_next_free_sgpr 102
  .amdhsa_accum_offset 256
  .amdhsa_group_segment_fixed_size 0
  .amdhsa_kernarg_size 88
  .amdhsa_user_sgpr_count 2
  .amdhsa_user_sgpr_kernarg_segment_ptr 1
  .amdhsa_system_sgpr_workgroup_id_x 1
.end_amdhsa_kernel
```
